```python
import torch

def _softmax(x, axis=-1):
    return torch.softmax(x, dim=axis)
def _gelu(x):
    return torch.nn.functional.gelu(x, approximate="tanh")
def _silu(x):
    return torch.nn.functional.silu(x)
def _sigmoid(x):
    return torch.sigmoid(x)
def _layernorm(x, axis=-1, eps=1e-5):
    m = x.mean(dim=axis, keepdim=True)
    v = x.var(dim=axis, keepdim=True, unbiased=False)
    return (x - m) / torch.sqrt(v + eps)
def _scatter_add(tgt, idx, src, axis=0):
    return tgt.clone().index_add_(axis, idx, src)
def _segment_sum(src, seg, n):
    out = torch.zeros((n,) + src.shape[1:], dtype=src.dtype)
    return out.index_add_(0, seg, src)
def _pad(x, pw):
    flat = tuple(v for pair in reversed(pw) for v in pair)
    return torch.nn.functional.pad(x, flat)

kernel_name = 'parallel_sum__ssm_conv_h3__dense_activation_silu__prompt'

def setup_inputs():

    _w = (lambda a: (lambda t: t.to(torch.bfloat16) if t.is_floating_point() else t)(torch.as_tensor(a)))
    def _A_setup():
        B, S, D = 1, 2048, 448
        ks = 4
        return {
            "q": _w((lambda *s: torch.randn(*s, dtype=torch.bfloat16) * 0.05)(B, S, D)),
            "k": _w((lambda *s: torch.randn(*s, dtype=torch.bfloat16) * 0.2)(B, S, D)),
            "v": _w((lambda *s: torch.randn(*s, dtype=torch.bfloat16) * 0.2)(B, S, D)),
            "shift_k": _w((lambda *s: torch.randn(*s, dtype=torch.bfloat16) * 0.2)(D, ks) * 0.5),
            "ssm_k": _w((lambda *s: torch.randn(*s, dtype=torch.bfloat16) * 0.4)(D, S) * (1.0 / S ** 0.5)),
            "ssm_D": _w((lambda *s: torch.randn(*s, dtype=torch.bfloat16) * 0.2)(D)),
        }
    _A_in = _A_setup()

    def _B_setup():
        B, S, D, F = 1, 2048, 448, 1792
        return {
            "x": _w((lambda *s: torch.randn(*s, dtype=torch.bfloat16) * 0.05)(B, S, D)),
            "w1": _w((lambda *s: torch.randn(*s, dtype=torch.bfloat16) * 0.8)(D, F) * (D ** -0.5)),
            "w2": _w((lambda *s: torch.randn(*s, dtype=torch.bfloat16) * 0.1)(F, D) * (F ** -0.5)),
        }
    _B_in = _B_setup()

    return {
        "A_q": _A_in["q"],
        "A_k": _A_in["k"],
        "A_v": _A_in["v"],
        "A_shift_k": _A_in["shift_k"],
        "A_ssm_k": _A_in["ssm_k"],
        "A_ssm_D": _A_in["ssm_D"],
        "B_x": _B_in["x"],
        "B_w1": _B_in["w1"],
        "B_w2": _B_in["w2"],
    }

def reference(A_q, A_k, A_v, A_shift_k, A_ssm_k, A_ssm_D, B_x, B_w1, B_w2):
    def _A_ref(q, k, v, shift_k, ssm_k, ssm_D):
        B, S, D = q.shape
        ks = shift_k.shape[-1]
        k_pad = _pad(k, ((0, 0), (ks - 1, 0), (0, 0)))
        k_shift = torch.zeros_like(k)
        for t in range(ks):
            k_shift = k_shift + k_pad[:, t:t + S, :] * shift_k[:, ks - 1 - t][None, None, :]
        kv = k_shift * v
        L = 2 * S
        kv_pad = _pad(kv, ((0, 0), (0, S), (0, 0)))
        kf_pad = _pad(ssm_k, ((0, 0), (0, S)))
        kv_f = (lambda x, axes=(-2,-1): torch.fft.rfft2(x.float(), dim=axes))(kv_pad[:, None, :, :], axes=(1, 2))
        kf_f = (lambda x, axes=(-2,-1): torch.fft.rfft2(x.float(), dim=axes))(kf_pad[:, None, :], axes=(1, 2))
        kf_f = (lambda x, *d: x.permute(*d))(kf_f, 1, 2, 0)
        y_f = kv_f * kf_f[None, :, :, :]
        y = (lambda x, s, axes=(-2,-1): torch.fft.irfft2(x, s=s, dim=axes).to(torch.bfloat16))(y_f, (1, L), axes=(1, 2))[:, 0, :S, :]
        y = y + kv * ssm_D[None, None, :]
        return q * y

    def _B_ref(x, w1, w2):
        h = torch.einsum("bsd,df->bsf", x, w1)
        h = _silu(h)
        out = torch.einsum("bsf,fd->bsd", h, w2)
        return out

    x = A_q
    xn = _layernorm(x, axis=-1)
    return x + _A_ref(xn, A_k, A_v, A_shift_k, A_ssm_k, A_ssm_D) + _B_ref(xn, B_w1, B_w2)
```

```asm
; @launch grid=(256,1,1) block=(512,1,1) lds=163840
.amdgcn_target "amdgcn-amd-amdhsa--gfx950"
.text
.globl parallel_sum__ssm_conv_h3__dense_activation_silu__prompt_kernel
.p2align 8
.type parallel_sum__ssm_conv_h3__dense_activation_silu__prompt_kernel,@function
parallel_sum__ssm_conv_h3__dense_activation_silu__prompt_kernel:
    s_cmp_ge_u32 s2, 256
    s_cbranch_scc1 L_END
    s_load_dwordx16 s[4:19], s[0:1], 0
    s_load_dwordx8 s[20:27], s[0:1], 64
    s_memrealtime s[76:77]
    v_lshrrev_b32 v1, 6, v0
    v_and_b32 v0, 63, v0
    v_readfirstlane_b32 s28, v1
    s_cmp_lt_u32 s2, 8
    s_cbranch_scc0 L_NOPF
    s_getpc_b64 s[30:31]
    s_lshl_b32 s29, s28, 13
    v_lshlrev_b32 v2, 7, v0
    v_add_u32 v2, s29, v2
    s_mov_b32 s29, L_CODE_END-L_PCREF
    v_min_u32 v2, s29, v2
L_PCREF:
    global_load_dword v255, v2, s[30:31]
L_NOPF:
    s_cmp_lt_u32 s2, 32
    s_cbranch_scc1 L_HELP
    s_sub_u32 s31, s2, 32
    s_and_b32 s70, s31, 7
    s_lshr_b32 s71, s31, 3
    s_cmp_ge_u32 s71, 14
    s_cselect_b32 s72, 1, 0
    s_mul_i32 s73, s72, 14
    s_sub_u32 s65, s71, s73
    s_lshl_b32 s64, s70, 1
    s_add_u32 s64, s64, s72
    s_cmp_ge_u32 s65, 7
    s_cselect_b32 s67, 1, 0
    s_mul_i32 s73, s67, 7
    s_sub_u32 s66, s65, s73
    s_lshl_b32 s73, s72, 1
    s_add_u32 s73, s73, s67
    s_lshl_b32 s73, s73, 1
    s_add_u32 s73, s73, s66
    s_sub_u32 s71, s73, 7
    s_cselect_b32 s69, s73, s71
    s_cmp_eq_u32 s70, 7
    s_cselect_b32 s92, 3, s70
    s_cmp_ge_u32 s28, 4
    s_cbranch_scc1 L_G
    s_setprio 1
    v_lshrrev_b32 v20, 3, v0
    v_and_b32 v21, 7, v0
    v_lshrrev_b32 v22, 4, v0
    v_mul_u32_u24 v24, 896, v20
    v_lshrrev_b32 v25, 2, v0
    v_and_b32 v26, 3, v0
    v_xor_b32 v23, v21, v22
    v_lshl_add_u32 v1, v23, 4, v24
    v_xor_b32 v23, 4, v23
    v_lshl_add_u32 v2, v23, 4, v24
    v_add_u32 v2, 7168, v2
    v_add_u32 v3, 14336, v1
    v_add_u32 v4, 14336, v2
    v_mul_u32_u24 v5, 3584, v25
    v_lshl_add_u32 v5, v26, 4, v5
    v_lshl_add_u32 v6, v21, 4, v24
    s_lshl_b32 s70, s64, 2
    s_add_u32 s70, s70, s28
    s_mul_i32 s93, s70, 32*896
    s_mul_i32 s94, s28, 16*3584
    s_lshl_b32 s72, s65, 8
    s_add_u32 s94, s94, s72
    s_lshl_b32 s95, s28, 12
    s_lshl_b32 s96, s28, 10
    s_add_u32 s96, s96, 16384
    s_mul_i32 s29, s31, 9363
    s_lshr_b32 s29, s29, 16
    s_mul_i32 s70, s29, 7
    s_sub_u32 s30, s31, s70
    s_mul_i32 s74, s29, 64*896
    s_lshl_b32 s70, s30, 7
    s_add_u32 s74, s74, s70
    v_and_b32 v27, 15, v0
    v_lshlrev_b32 v28, 3, v27
    s_waitcnt lgkmcnt(0)
    s_mov_b32 s32, s4
    s_mov_b32 s33, s5
    s_mov_b32 s34, 1835008
    s_mov_b32 s35, 0x20000
    s_mov_b32 s36, s18
    s_mov_b32 s37, s19
    s_mov_b32 s38, 1605632
    s_mov_b32 s39, 0x20000
    s_mov_b32 s40, s6
    s_mov_b32 s41, s7
    s_mov_b32 s42, 1835008
    s_mov_b32 s43, 0x20000
    s_cmp_eq_u32 s28, 0
    s_cbranch_scc0 NOHALO_1
    s_sub_u32 s70, s74, 8*896
    s_cmp_eq_u32 s29, 0
    s_cselect_b32 s70, 0x7ff00000, s70
    s_mov_b32 m0, 131072
    v_add_u32 v29, s70, v6
    buffer_load_dwordx4 v29, s[40:43], 0 offen lds
NOHALO_1:
    s_mov_b32 s56, s8
    s_mov_b32 s57, s9
    s_mov_b32 s58, 1835008
    s_mov_b32 s59, 0x20000
    s_mul_i32 s72, s28, 16*896
    s_add_u32 s72, s72, s74
    s_lshl_b32 s75, s28, 11
    s_add_u32 m0, s75, 132096
    s_add_u32 s73, s72, 8*896
    buffer_load_dwordx4 v6, s[40:43], s72 offen lds
    s_add_u32 m0, s75, 133120
    s_nop 0
    buffer_load_dwordx4 v6, s[40:43], s73 offen lds
    s_add_u32 m0, s75, 140288
    s_nop 0
    buffer_load_dwordx4 v6, s[56:59], s72 offen lds
    s_add_u32 m0, s75, 141312
    s_nop 0
    buffer_load_dwordx4 v6, s[56:59], s73 offen lds
    s_add_u32 m0, s95, 0
    s_lshl_b32 s70, s92, 7
    s_add_u32 s70, s70, s93
    buffer_load_dwordx4 v1, s[32:35], s70 offen lds
    s_add_u32 m0, s95, 1024
    s_nop 0
    buffer_load_dwordx4 v2, s[32:35], s70 offen lds
    s_add_u32 m0, s95, 2048
    s_mul_i32 s71, s92, 64*3584
    buffer_load_dwordx4 v3, s[32:35], s70 offen lds
    s_add_u32 m0, s95, 3072
    s_add_u32 s71, s71, s94
    buffer_load_dwordx4 v4, s[32:35], s70 offen lds
    s_add_u32 m0, s96, 0
    s_nop 0
    buffer_load_dwordx4 v5, s[36:39], s71 offen offset:0 lds
    s_add_u32 m0, s96, 4032
    s_add_u32 s92, s92, 1
    buffer_load_dwordx4 v5, s[36:39], s71 offen offset:64 lds
    s_add_u32 m0, s96, 8064
    s_cmp_eq_u32 s92, 7
    s_cselect_b32 s92, 0, s92
    buffer_load_dwordx4 v5, s[36:39], s71 offen offset:128 lds
    s_add_u32 m0, s96, 12096
    s_nop 0
    buffer_load_dwordx4 v5, s[36:39], s71 offen offset:192 lds
    v_mov_b32 v32, 0
    v_mov_b32 v33, 0
    v_mov_b32 v34, 0
    v_mov_b32 v35, 0
    v_mov_b32 v31, 161792
    ds_write_b128 v31, v[32:35]
    ds_write_b128 v31, v[32:35] offset:16
    ds_write_b128 v31, v[32:35] offset:32
    ds_write_b128 v31, v[32:35] offset:48
    ds_write_b128 v31, v[32:35] offset:64
    ds_write_b128 v31, v[32:35] offset:80
    ds_write_b128 v31, v[32:35] offset:96
    ds_write_b128 v31, v[32:35] offset:112
    ds_write_b128 v31, v[32:35] offset:128
    ds_write_b128 v31, v[32:35] offset:144
    v_mov_b32 v15, 161792
    v_cmp_eq_u32 vcc, 0, v0
    v_mov_b32 v17, 1
    v_lshlrev_b32 v19, 2, v0
    v_add_u32 v19, 162048, v19
    v_cndmask_b32 v19, v19, v15, vcc
    s_waitcnt vmcnt(8)
    s_waitcnt lgkmcnt(0)
    s_barrier
    s_add_u32 m0, s95, 32768
    s_lshl_b32 s70, s92, 7
    s_add_u32 s70, s70, s93
    buffer_load_dwordx4 v1, s[32:35], s70 offen lds
    s_add_u32 m0, s95, 33792
    s_nop 0
    buffer_load_dwordx4 v2, s[32:35], s70 offen lds
    s_add_u32 m0, s95, 34816
    s_mul_i32 s71, s92, 64*3584
    buffer_load_dwordx4 v3, s[32:35], s70 offen lds
    s_add_u32 m0, s95, 35840
    s_add_u32 s71, s71, s94
    buffer_load_dwordx4 v4, s[32:35], s70 offen lds
    s_add_u32 m0, s96, 32768
    s_nop 0
    buffer_load_dwordx4 v5, s[36:39], s71 offen offset:0 lds
    s_add_u32 m0, s96, 36800
    s_add_u32 s92, s92, 1
    buffer_load_dwordx4 v5, s[36:39], s71 offen offset:64 lds
    s_add_u32 m0, s96, 40832
    s_cmp_eq_u32 s92, 7
    s_cselect_b32 s92, 0, s92
    buffer_load_dwordx4 v5, s[36:39], s71 offen offset:128 lds
    s_add_u32 m0, s96, 44864
    s_nop 0
    buffer_load_dwordx4 v5, s[36:39], s71 offen offset:192 lds
    s_waitcnt vmcnt(8)
    ds_add_u32 v19, v17 offset:96
    s_add_u32 m0, s95, 65536
    s_lshl_b32 s70, s92, 7
    s_add_u32 s70, s70, s93
    buffer_load_dwordx4 v1, s[32:35], s70 offen lds
    v_lshlrev_b32 v9, 4, v0
    v_cmp_eq_u32 vcc, 0, v0
    v_mov_b32 v10, 0x7fffffff
    s_nop 0
    v_cndmask_b32 v10, v10, 0, vcc
    s_add_u32 m0, s95, 66560
    s_nop 0
    buffer_load_dwordx4 v2, s[32:35], s70 offen lds
    v_mov_b32 v11, 0
    s_add_u32 s48, s26, 12582912
    s_addc_u32 s49, s27, 0
    s_mov_b32 s50, 196608
    s_add_u32 m0, s95, 67584
    s_mul_i32 s71, s92, 64*3584
    buffer_load_dwordx4 v3, s[32:35], s70 offen lds
    s_mov_b32 s51, 0x20000
    s_mov_b32 s52, s24
    s_mov_b32 s53, s25
    s_mov_b32 s54, 256
    s_add_u32 m0, s95, 68608
    s_add_u32 s71, s71, s94
    buffer_load_dwordx4 v4, s[32:35], s70 offen lds
    s_mov_b32 s55, 0x20000
    s_lshr_b32 s72, s28, 1
    s_and_b32 s98, s28, 1
    s_lshl_b32 s97, s31, 1
    s_add_u32 m0, s96, 65536
    s_nop 0
    buffer_load_dwordx4 v5, s[36:39], s71 offen offset:0 lds
    s_add_u32 s97, s97, s72
    s_mul_i32 s99, s72, 8960
    s_add_u32 s99, s99, 98304
    s_mul_i32 s100, s72, 9120
    s_add_u32 m0, s96, 69568
    s_add_u32 s92, s92, 1
    buffer_load_dwordx4 v5, s[36:39], s71 offen offset:64 lds
    s_add_u32 s100, s100, 131072
    s_lshl_b32 s73, s97, 12
    s_add_u32 s40, s12, s73
    s_addc_u32 s41, s13, 0
    s_add_u32 m0, s96, 73600
    s_cmp_eq_u32 s92, 7
    s_cselect_b32 s92, 0, s92
    buffer_load_dwordx4 v5, s[36:39], s71 offen offset:128 lds
    s_mov_b32 s42, 4096
    s_mov_b32 s43, 0x20000
    s_add_u32 s44, s26, s73
    s_addc_u32 s45, s27, 0
    s_add_u32 m0, s96, 77632
    s_nop 0
    buffer_load_dwordx4 v5, s[36:39], s71 offen offset:192 lds
    s_mov_b32 s46, 4096
    s_mov_b32 s47, 0x20000
    s_add_u32 s73, s73, 2097152
    s_add_u32 s60, s26, s73
    s_addc_u32 s61, s27, 0
    s_add_u32 m0, s95, 98304
    s_lshl_b32 s70, s92, 7
    s_add_u32 s70, s70, s93
    buffer_load_dwordx4 v1, s[32:35], s70 offen lds
    s_mov_b32 s62, 4096
    s_mov_b32 s63, 0x20000
    s_mov_b32 s4, s14
    s_mov_b32 s5, s15
    s_add_u32 m0, s95, 99328
    s_nop 0
    buffer_load_dwordx4 v2, s[32:35], s70 offen lds
    s_mov_b32 s6, 896
    s_mov_b32 s7, 0x20000
    s_lshl_b32 s73, s98, 11
    v_add_u32 v225, s73, v9
    s_add_u32 m0, s95, 100352
    s_mul_i32 s71, s92, 64*3584
    buffer_load_dwordx4 v3, s[32:35], s70 offen lds
    v_and_b32 v30, 31, v0
    v_lshlrev_b32 v227, 2, v30
    s_add_u32 m0, s95, 101376
    s_add_u32 s71, s71, s94
    buffer_load_dwordx4 v4, s[32:35], s70 offen lds
    s_waitcnt vmcnt(12)
    ds_add_u32 v19, v17 offset:100
    s_add_u32 m0, s96, 98304
    s_nop 0
    buffer_load_dwordx4 v5, s[36:39], s71 offen offset:0 lds
    s_add_u32 m0, s96, 102336
    s_add_u32 s92, s92, 1
    buffer_load_dwordx4 v5, s[36:39], s71 offen offset:64 lds
    s_add_u32 m0, s96, 106368
    s_cmp_eq_u32 s92, 7
    s_cselect_b32 s92, 0, s92
    buffer_load_dwordx4 v5, s[36:39], s71 offen offset:128 lds
    s_add_u32 m0, s96, 110400
    s_nop 0
    buffer_load_dwordx4 v5, s[36:39], s71 offen offset:192 lds
    buffer_load_dword v12, v11, s[52:55], 0 offen sc1
    ds_read_b32 v40, v15 offset:128
    s_waitcnt lgkmcnt(0)
    v_cmp_le_u32 vcc, 4, v40
    s_mov_b32 s73, 0
    s_cbranch_vccnz FREE_2
    s_waitcnt vmcnt(9)
    ds_add_u32 v19, v17 offset:104
    s_mov_b32 s73, 1
    s_movk_i32 s101, 32767
GLP_5:
    ds_read_b32 v40, v15 offset:128
    s_waitcnt lgkmcnt(0)
    v_cmp_le_u32 vcc, 4, v40
    s_cbranch_vccnz GOK_4
    s_sleep 2
    s_sub_u32 s101, s101, 1
    s_cbranch_scc0 GLP_5
GOK_4:
FREE_2:
    s_add_u32 m0, s95, 0
    s_lshl_b32 s70, s92, 7
    s_add_u32 s70, s70, s93
    buffer_load_dwordx4 v1, s[32:35], s70 offen lds
    s_add_u32 m0, s95, 1024
    s_nop 0
    buffer_load_dwordx4 v2, s[32:35], s70 offen lds
    s_add_u32 m0, s95, 2048
    s_mul_i32 s71, s92, 64*3584
    buffer_load_dwordx4 v3, s[32:35], s70 offen lds
    s_add_u32 m0, s95, 3072
    s_add_u32 s71, s71, s94
    buffer_load_dwordx4 v4, s[32:35], s70 offen lds
    s_cmp_eq_u32 s73, 1
    s_cbranch_scc1 SIGD_3
    s_waitcnt vmcnt(13)
    ds_add_u32 v19, v17 offset:104
SIGD_3:
    s_add_u32 m0, s96, 0
    s_nop 0
    buffer_load_dwordx4 v5, s[36:39], s71 offen offset:0 lds
    s_add_u32 m0, s96, 4032
    s_add_u32 s92, s92, 1
    buffer_load_dwordx4 v5, s[36:39], s71 offen offset:64 lds
    s_add_u32 m0, s96, 8064
    s_cmp_eq_u32 s92, 7
    s_cselect_b32 s92, 0, s92
    buffer_load_dwordx4 v5, s[36:39], s71 offen offset:128 lds
    s_add_u32 m0, s96, 12096
    s_nop 0
    buffer_load_dwordx4 v5, s[36:39], s71 offen offset:192 lds
    ds_read_b32 v40, v15 offset:132
    s_waitcnt lgkmcnt(0)
    v_cmp_le_u32 vcc, 4, v40
    s_mov_b32 s73, 0
    s_cbranch_vccnz FREE_6
    s_waitcnt vmcnt(9)
    ds_add_u32 v19, v17 offset:108
    s_mov_b32 s73, 1
    s_movk_i32 s101, 32767
GLP_9:
    ds_read_b32 v40, v15 offset:132
    s_waitcnt lgkmcnt(0)
    v_cmp_le_u32 vcc, 4, v40
    s_cbranch_vccnz GOK_8
    s_sleep 2
    s_sub_u32 s101, s101, 1
    s_cbranch_scc0 GLP_9
GOK_8:
FREE_6:
    s_add_u32 m0, s95, 32768
    s_lshl_b32 s70, s92, 7
    s_add_u32 s70, s70, s93
    buffer_load_dwordx4 v1, s[32:35], s70 offen lds
    s_add_u32 m0, s95, 33792
    s_nop 0
    buffer_load_dwordx4 v2, s[32:35], s70 offen lds
    s_add_u32 m0, s95, 34816
    s_mul_i32 s71, s92, 64*3584
    buffer_load_dwordx4 v3, s[32:35], s70 offen lds
    s_add_u32 m0, s95, 35840
    s_add_u32 s71, s71, s94
    buffer_load_dwordx4 v4, s[32:35], s70 offen lds
    s_cmp_eq_u32 s73, 1
    s_cbranch_scc1 SIGD_7
    s_waitcnt vmcnt(13)
    ds_add_u32 v19, v17 offset:108
SIGD_7:
    s_add_u32 m0, s96, 32768
    s_nop 0
    buffer_load_dwordx4 v5, s[36:39], s71 offen offset:0 lds
    s_add_u32 m0, s96, 36800
    s_add_u32 s92, s92, 1
    buffer_load_dwordx4 v5, s[36:39], s71 offen offset:64 lds
    s_add_u32 m0, s96, 40832
    s_cmp_eq_u32 s92, 7
    s_cselect_b32 s92, 0, s92
    buffer_load_dwordx4 v5, s[36:39], s71 offen offset:128 lds
    s_add_u32 m0, s96, 44864
    s_nop 0
    buffer_load_dwordx4 v5, s[36:39], s71 offen offset:192 lds
    ds_read_b32 v40, v15 offset:136
    s_waitcnt lgkmcnt(0)
    v_cmp_le_u32 vcc, 4, v40
    s_mov_b32 s73, 0
    s_cbranch_vccnz FREE_10
    s_waitcnt vmcnt(8)
    ds_add_u32 v19, v17 offset:112
    s_mov_b32 s73, 1
    s_movk_i32 s101, 32767
GLP_13:
    ds_read_b32 v40, v15 offset:136
    s_waitcnt lgkmcnt(0)
    v_cmp_le_u32 vcc, 4, v40
    s_cbranch_vccnz GOK_12
    s_sleep 2
    s_sub_u32 s101, s101, 1
    s_cbranch_scc0 GLP_13
GOK_12:
FREE_10:
    s_add_u32 m0, s95, 65536
    s_lshl_b32 s70, s92, 7
    s_add_u32 s70, s70, s93
    buffer_load_dwordx4 v1, s[32:35], s70 offen lds
    s_add_u32 m0, s95, 66560
    s_nop 0
    buffer_load_dwordx4 v2, s[32:35], s70 offen lds
    s_add_u32 m0, s95, 67584
    s_mul_i32 s71, s92, 64*3584
    buffer_load_dwordx4 v3, s[32:35], s70 offen lds
    s_add_u32 m0, s95, 68608
    s_add_u32 s71, s71, s94
    buffer_load_dwordx4 v4, s[32:35], s70 offen lds
    s_cmp_eq_u32 s73, 1
    s_cbranch_scc1 SIGD_11
    s_waitcnt vmcnt(12)
    ds_add_u32 v19, v17 offset:112
SIGD_11:
    s_add_u32 m0, s96, 65536
    s_nop 0
    buffer_load_dwordx4 v5, s[36:39], s71 offen offset:0 lds
    s_add_u32 m0, s96, 69568
    s_add_u32 s92, s92, 1
    buffer_load_dwordx4 v5, s[36:39], s71 offen offset:64 lds
    s_add_u32 m0, s96, 73600
    s_cmp_eq_u32 s92, 7
    s_cselect_b32 s92, 0, s92
    buffer_load_dwordx4 v5, s[36:39], s71 offen offset:128 lds
    s_add_u32 m0, s96, 77632
    s_nop 0
    buffer_load_dwordx4 v5, s[36:39], s71 offen offset:192 lds
    s_mov_b32 s32, s20
    s_mov_b32 s33, s21
    s_mov_b32 s34, 1605632
    s_mov_b32 s35, 0x20000
    v_lshrrev_b32 v1, 2, v0
    v_and_b32 v2, 3, v0
    v_mul_u32_u24 v1, 896, v1
    v_lshl_add_u32 v1, v2, 4, v1
    s_lshr_b32 s71, s28, 1
    s_lshl_b32 s72, s71, 2
    s_add_u32 s72, s72, s98
    s_mul_i32 s70, s72, 14336
    s_lshl_b32 s72, s66, 7
    s_add_u32 s70, s70, s72
    s_lshl_b32 s71, s71, 6
    s_add_u32 s92, s70, s71
    s_xor_b32 s71, s71, 64
    s_add_u32 s93, s70, s71
    s_lshl_b32 s94, s28, 13
    s_lshl_b32 s95, s69, 1
    s_lshl_b32 s70, s28, 2
    s_add_u32 s70, s70, 161840
    v_mov_b32 v3, s70
    s_waitcnt vmcnt(8)
    ds_add_u32 v19, v17 offset:116
    s_waitcnt vmcnt(0)
    ds_add_u32 v19, v17 offset:120
    s_movk_i32 s101, 32767
GLP_15:
    ds_read_b32 v40, v15 offset:140
    s_waitcnt lgkmcnt(0)
    v_cmp_le_u32 vcc, 4, v40
    s_cbranch_vccnz GOK_14
    s_sleep 2
    s_sub_u32 s101, s101, 1
    s_cbranch_scc0 GLP_15
GOK_14:
    s_lshl_b32 s73, s98, 2
    s_sub_u32 s73, 60, s73
    v_lshlrev_b32 v30, 2, v0
    v_subrev_u32 v30, s73, v30
    s_sub_u32 s73, 256, s73
    v_add_u32 v31, s73, v9
    s_mul_i32 s73, s98, 4480
    s_add_u32 s73, s73, s99
    s_mov_b32 m0, s73
    s_lshl_b32 s72, s97, 1
    buffer_load_dword v30, s[40:43], 0 offen lds
    s_add_u32 m0, s73, 256
    buffer_load_ushort v224, v11, s[4:7], s72 offen
    buffer_load_dwordx4 v31, s[40:43], 0 offen offset:0 lds
    buffer_load_dwordx4 v31, s[40:43], 0 offen offset:1024 lds
    buffer_load_dwordx4 v31, s[40:43], 0 offen offset:2048 lds
    buffer_load_dwordx4 v31, s[40:43], 0 offen offset:3072 lds
    v_add_u32 v18, s100, v225
    v_and_b32 v5, 15, v0
    v_lshrrev_b32 v6, 4, v0
    v_and_b32 v36, 1, v5
    v_lshrrev_b32 v37, 1, v5
    s_lshl_b32 s72, s98, 8
    s_add_u32 s70, s72, s100
    s_add_u32 s71, s72, s99
    v_mul_u32_u24 v38, 4576, v36
    v_lshlrev_b32 v39, 6, v37
    v_sub_u32 v35, v38, v39
    v_lshl_add_u32 v38, v6, 4, v35
    v_add_u32 v38, 448, v38
    v_add_u32 v38, s70, v38
    v_mul_u32_u24 v39, 4480, v36
    v_lshl_add_u32 v39, v37, 3, v39
    v_lshl_add_u32 v39, v6, 4, v39
    v_add_u32 v39, s71, v39
    s_lshl_b32 s70, s28, 2
    s_add_u32 s70, s70, 161792
    v_mov_b32 v33, s70
    v_xor_b32 v34, 4, v33
    s_lshr_b32 s72, s28, 1
    s_mul_i32 s72, s72, 33088
    s_add_u32 s72, s72, 116224
    s_lshl_b32 s70, s98, 12
    s_add_u32 s71, s70, s72
    v_add_u32 v20, s71, v9
    s_xor_b32 s70, s70, 4096
    s_add_u32 s71, s70, s72
    v_add_u32 v21, s71, v9
    v_lshlrev_b32 v23, 4, v6
    v_sub_u32 v22, v35, v23
    s_lshl_b32 s72, s98, 11
    s_sub_u32 s72, s100, s72
    s_add_u32 s72, s72, 2544
    v_add_u32 v22, s72, v22
    v_cmp_eq_u32 vcc, 1, v36
    v_mov_b32 v24, 0x05040100
    v_mov_b32 v25, 0x01000504
    v_mov_b32 v26, 0x03020706
    v_mov_b32 v27, 0x07060302
    v_cndmask_b32 v24, v24, v25, vcc
    v_cndmask_b32 v25, v27, v26, vcc
    v_lshlrev_b32 v28, 6, v37
    v_lshl_add_u32 v28, v6, 4, v28
    v_lshl_add_u32 v28, v36, 3, v28
    v_add_u32 v28, s71, v28
    s_lshr_b32 s18, s97, 5
    s_lshl_b32 s18, s18, 1
    s_add_u32 s18, s18, s98
    s_lshl_b32 s18, s18, 7
    s_and_b32 s70, s97, 31
    s_lshl_b32 s70, s70, 2
    s_add_u32 s18, s18, s70
    s_add_u32 s18, s18, 8192
    v_mov_b32 v40, 0
    v_mov_b32 v41, 0
    v_mov_b32 v42, 0
    v_mov_b32 v43, 0
    s_mul_i32 s72, s98, 4576
    s_add_u32 s72, s72, s100
    s_add_u32 s72, s72, 4096
    v_min_u32 v30, 432, v9
    v_add_u32 v30, s72, v30
    ds_write_b128 v30, v[40:43]
    s_movk_i32 s101, 32767
LP_17:
    v_readfirstlane_b32 s77, v12
    s_nop 1
    s_cmp_lg_u32 s77, 0
    s_cbranch_scc1 OK_16
    s_sub_u32 s101, s101, 1
    s_cbranch_scc1 OK_16
    s_sleep 1
    buffer_load_dword v12, v11, s[52:55], 0 offen sc1
    s_waitcnt vmcnt(0)
    s_branch LP_17
OK_16:
    v_mov_b32 v12, s77
    s_movk_i32 s101, 32767
GLP_19:
    ds_read_b32 v40, v15 offset:144
    s_waitcnt lgkmcnt(0)
    v_cmp_le_u32 vcc, 4, v40
    s_cbranch_vccnz GOK_18
    s_sleep 2
    s_sub_u32 s101, s101, 1
    s_cbranch_scc0 GLP_19
GOK_18:
    s_add_u32 s96, s95, 0
    s_sub_u32 s70, s96, 14
    s_cselect_b32 s96, s96, s70
    s_mul_i32 s96, s96, 8*14336
    s_add_u32 m0, s94, 0
    s_add_u32 s70, s96, s92
    buffer_load_dwordx4 v1, s[32:35], s70 offen lds
    s_add_u32 m0, s94, 1024
    s_add_u32 s70, s96, s93
    buffer_load_dwordx4 v1, s[32:35], s70 offen lds
    s_add_u32 s96, s95, 1
    s_sub_u32 s70, s96, 14
    s_cselect_b32 s96, s96, s70
    s_mul_i32 s96, s96, 8*14336
    s_add_u32 m0, s94, 2048
    s_add_u32 s70, s96, s92
    buffer_load_dwordx4 v1, s[32:35], s70 offen lds
    s_add_u32 m0, s94, 3072
    s_add_u32 s70, s96, s93
    buffer_load_dwordx4 v1, s[32:35], s70 offen lds
    s_add_u32 s96, s95, 2
    s_sub_u32 s70, s96, 14
    s_cselect_b32 s96, s96, s70
    s_mul_i32 s96, s96, 8*14336
    s_add_u32 m0, s94, 4096
    s_add_u32 s70, s96, s92
    buffer_load_dwordx4 v1, s[32:35], s70 offen lds
    s_add_u32 m0, s94, 5120
    s_add_u32 s70, s96, s93
    buffer_load_dwordx4 v1, s[32:35], s70 offen lds
    s_add_u32 s96, s95, 3
    s_sub_u32 s70, s96, 14
    s_cselect_b32 s96, s96, s70
    s_mul_i32 s96, s96, 8*14336
    s_add_u32 m0, s94, 6144
    s_add_u32 s70, s96, s92
    buffer_load_dwordx4 v1, s[32:35], s70 offen lds
    s_add_u32 m0, s94, 7168
    s_add_u32 s70, s96, s93
    buffer_load_dwordx4 v1, s[32:35], s70 offen lds
    s_movk_i32 s101, 32767
GLP_21:
    ds_read_b32 v40, v15 offset:148
    s_waitcnt lgkmcnt(0)
    v_cmp_le_u32 vcc, 4, v40
    s_cbranch_vccnz GOK_20
    s_sleep 2
    s_sub_u32 s101, s101, 1
    s_cbranch_scc0 GLP_21
GOK_20:
    s_add_u32 s96, s95, 4
    s_sub_u32 s70, s96, 14
    s_cselect_b32 s96, s96, s70
    s_mul_i32 s96, s96, 8*14336
    s_add_u32 m0, s94, 32768
    s_add_u32 s70, s96, s92
    buffer_load_dwordx4 v1, s[32:35], s70 offen lds
    s_add_u32 m0, s94, 33792
    s_add_u32 s70, s96, s93
    buffer_load_dwordx4 v1, s[32:35], s70 offen lds
    s_add_u32 s96, s95, 5
    s_sub_u32 s70, s96, 14
    s_cselect_b32 s96, s96, s70
    s_mul_i32 s96, s96, 8*14336
    s_add_u32 m0, s94, 34816
    s_add_u32 s70, s96, s92
    buffer_load_dwordx4 v1, s[32:35], s70 offen lds
    s_add_u32 m0, s94, 35840
    s_add_u32 s70, s96, s93
    buffer_load_dwordx4 v1, s[32:35], s70 offen lds
    s_add_u32 s96, s95, 6
    s_sub_u32 s70, s96, 14
    s_cselect_b32 s96, s96, s70
    s_mul_i32 s96, s96, 8*14336
    s_add_u32 m0, s94, 36864
    s_add_u32 s70, s96, s92
    buffer_load_dwordx4 v1, s[32:35], s70 offen lds
    s_add_u32 m0, s94, 37888
    s_add_u32 s70, s96, s93
    buffer_load_dwordx4 v1, s[32:35], s70 offen lds
    s_add_u32 s96, s95, 7
    s_sub_u32 s70, s96, 14
    s_cselect_b32 s96, s96, s70
    s_mul_i32 s96, s96, 8*14336
    s_add_u32 m0, s94, 38912
    s_add_u32 s70, s96, s92
    buffer_load_dwordx4 v1, s[32:35], s70 offen lds
    s_add_u32 m0, s94, 39936
    s_add_u32 s70, s96, s93
    buffer_load_dwordx4 v1, s[32:35], s70 offen lds
    s_lshr_b32 s17, s97, 4
    s_lshl_b32 s17, s17, 7
    buffer_load_dword v226, v227, s[48:51], s17 offen sc1
    s_movk_i32 s101, 32767
GLP_23:
    ds_read_b32 v40, v15 offset:152
    s_waitcnt lgkmcnt(0)
    v_cmp_le_u32 vcc, 4, v40
    s_cbranch_vccnz GOK_22
    s_sleep 2
    s_sub_u32 s101, s101, 1
    s_cbranch_scc0 GLP_23
GOK_22:
    s_add_u32 s96, s95, 8
    s_sub_u32 s70, s96, 14
    s_cselect_b32 s96, s96, s70
    s_mul_i32 s96, s96, 8*14336
    s_add_u32 m0, s94, 65536
    s_add_u32 s70, s96, s92
    buffer_load_dwordx4 v1, s[32:35], s70 offen lds
    s_add_u32 m0, s94, 66560
    s_add_u32 s70, s96, s93
    buffer_load_dwordx4 v1, s[32:35], s70 offen lds
    s_add_u32 s96, s95, 9
    s_sub_u32 s70, s96, 14
    s_cselect_b32 s96, s96, s70
    s_mul_i32 s96, s96, 8*14336
    s_add_u32 m0, s94, 67584
    s_add_u32 s70, s96, s92
    buffer_load_dwordx4 v1, s[32:35], s70 offen lds
    s_add_u32 m0, s94, 68608
    s_add_u32 s70, s96, s93
    buffer_load_dwordx4 v1, s[32:35], s70 offen lds
    s_add_u32 s96, s95, 10
    s_sub_u32 s70, s96, 14
    s_cselect_b32 s96, s96, s70
    s_mul_i32 s96, s96, 8*14336
    s_add_u32 m0, s94, 69632
    s_add_u32 s70, s96, s92
    buffer_load_dwordx4 v1, s[32:35], s70 offen lds
    s_add_u32 m0, s94, 70656
    s_add_u32 s70, s96, s93
    buffer_load_dwordx4 v1, s[32:35], s70 offen lds
    s_waitcnt vmcnt(6)
    v_cmp_eq_u32 vcc, s77, v226
    buffer_load_dwordx4 v[192:195], v225, s[44:47], 0 offen offset:0 sc1
    buffer_load_dwordx4 v[196:199], v225, s[44:47], 0 offen offset:4 sc1
    buffer_load_dwordx4 v[200:203], v225, s[44:47], 0 offen offset:1024 sc1
    buffer_load_dwordx4 v[204:207], v225, s[44:47], 0 offen offset:1028 sc1
    s_mov_b32 s16, vcc_lo
    s_waitcnt vmcnt(4)
    ds_write_b32 v33, v12 offset:64
    s_cmp_eq_u32 s16, -1
    s_cbranch_scc1 XOK_24
    buffer_load_dword v226, v227, s[48:51], s17 offen sc1
    s_waitcnt vmcnt(0)
    s_movk_i32 s101, 32767
LP_26:
    v_cmp_eq_u32 vcc, s77, v226
    s_nop 1
    s_cmp_eq_u32 vcc_lo, -1
    s_cbranch_scc1 OK_25
    s_sub_u32 s101, s101, 1
    s_cbranch_scc1 OK_25
    s_sleep 1
    buffer_load_dword v226, v227, s[48:51], s17 offen sc1
    s_waitcnt vmcnt(0)
    s_branch LP_26
OK_25:
    buffer_load_dwordx4 v[192:195], v225, s[44:47], 0 offen offset:0 sc1
    buffer_load_dwordx4 v[196:199], v225, s[44:47], 0 offen offset:4 sc1
    buffer_load_dwordx4 v[200:203], v225, s[44:47], 0 offen offset:1024 sc1
    buffer_load_dwordx4 v[204:207], v225, s[44:47], 0 offen offset:1028 sc1
    s_waitcnt vmcnt(0)
XOK_24:
    s_waitcnt vmcnt(2)
    ds_write_b128 v18, v[192:195] offset:4576
    v_alignbit_b32 v44, v196, v192, 16
    v_alignbit_b32 v45, v197, v193, 16
    v_alignbit_b32 v46, v198, v194, 16
    v_alignbit_b32 v47, v199, v195, 16
    ds_write_b128 v18, v[44:47] offset:0
    s_waitcnt vmcnt(0)
    ds_write_b128 v18, v[200:203] offset:5600
    v_alignbit_b32 v48, v204, v200, 16
    v_alignbit_b32 v49, v205, v201, 16
    v_alignbit_b32 v50, v206, v202, 16
    v_alignbit_b32 v51, v207, v203, 16
    ds_write_b128 v18, v[48:51] offset:1024
    s_setprio 0
    v_mov_b32 v32, 1
    s_waitcnt lgkmcnt(0)
    ds_write_b32 v33, v32
    s_movk_i32 s101, 32767
SLP_28:
    ds_read_b32 v31, v34
    s_waitcnt lgkmcnt(0)
    v_readfirstlane_b32 s70, v31
    s_nop 0
    s_cmp_ge_u32 s70, 1
    s_cbranch_scc1 SOK_27
    s_sleep 1
    s_sub_u32 s101, s101, 1
    s_cbranch_scc0 SLP_28
SOK_27:
    ds_read_b128 v[96:99], v38 offset:3584
    ds_read_b64 v[64:65], v39 offset:0
    ds_read_b64 v[66:67], v39 offset:8
    ds_read_b128 v[100:103], v38 offset:3072
    ds_read_b64 v[68:69], v39 offset:512
    ds_read_b64 v[70:71], v39 offset:520
    ds_read_b128 v[104:107], v38 offset:2560
    ds_read_b64 v[72:73], v39 offset:1024
    ds_read_b64 v[74:75], v39 offset:1032
    ds_read_b128 v[108:111], v38 offset:2048
    ds_read_b64 v[76:77], v39 offset:1536
    ds_read_b64 v[78:79], v39 offset:1544
    ds_read_b128 v[112:115], v38 offset:1536
    ds_read_b64 v[80:81], v39 offset:2048
    ds_read_b64 v[82:83], v39 offset:2056
    ds_read_b128 v[116:119], v38 offset:1024
    ds_read_b64 v[84:85], v39 offset:2560
    ds_read_b64 v[86:87], v39 offset:2568
    ds_read_b128 v[120:123], v38 offset:512
    ds_read_b64 v[88:89], v39 offset:3072
    ds_read_b64 v[90:91], v39 offset:3080
    ds_read_b128 v[124:127], v38 offset:0
    ds_read_b64 v[92:93], v39 offset:3584
    ds_read_b64 v[94:95], v39 offset:3592
    s_waitcnt lgkmcnt(15)
    v_mfma_f32_16x16x32_bf16 v[192:195], v[64:67], v[96:99], 0
    v_mfma_f32_16x16x32_bf16 v[196:199], v[64:67], v[100:103], 0
    v_mfma_f32_16x16x32_bf16 v[196:199], v[68:71], v[96:99], v[196:199]
    v_mfma_f32_16x16x32_bf16 v[200:203], v[68:71], v[100:103], 0
    v_mfma_f32_16x16x32_bf16 v[200:203], v[64:67], v[104:107], v[200:203]
    v_mfma_f32_16x16x32_bf16 v[200:203], v[72:75], v[96:99], v[200:203]
    v_mfma_f32_16x16x32_bf16 v[204:207], v[68:71], v[104:107], 0
    v_mfma_f32_16x16x32_bf16 v[204:207], v[72:75], v[100:103], v[204:207]
    v_mfma_f32_16x16x32_bf16 v[208:211], v[72:75], v[104:107], 0
    ds_read_b128 v[160:163], v38 offset:3648
    s_waitcnt lgkmcnt(13)
    v_mfma_f32_16x16x32_bf16 v[204:207], v[64:67], v[108:111], v[204:207]
    ds_read_b64 v[128:129], v39 offset:64
    v_mfma_f32_16x16x32_bf16 v[204:207], v[76:79], v[96:99], v[204:207]
    ds_read_b64 v[130:131], v39 offset:72
    v_mfma_f32_16x16x32_bf16 v[208:211], v[68:71], v[108:111], v[208:211]
    ds_read_b128 v[164:167], v38 offset:3136
    v_mfma_f32_16x16x32_bf16 v[208:211], v[76:79], v[100:103], v[208:211]
    ds_read_b64 v[132:133], v39 offset:576
    v_mfma_f32_16x16x32_bf16 v[212:215], v[72:75], v[108:111], 0
    ds_read_b64 v[134:135], v39 offset:584
    v_mfma_f32_16x16x32_bf16 v[212:215], v[76:79], v[104:107], v[212:215]
    ds_read_b128 v[168:171], v38 offset:2624
    v_mfma_f32_16x16x32_bf16 v[216:219], v[76:79], v[108:111], 0
    ds_read_b64 v[136:137], v39 offset:1088
    s_waitcnt lgkmcnt(15)
    v_mfma_f32_16x16x32_bf16 v[208:211], v[64:67], v[112:115], v[208:211]
    ds_read_b64 v[138:139], v39 offset:1096
    v_mfma_f32_16x16x32_bf16 v[208:211], v[80:83], v[96:99], v[208:211]
    ds_read_b128 v[172:175], v38 offset:2112
    v_mfma_f32_16x16x32_bf16 v[212:215], v[68:71], v[112:115], v[212:215]
    ds_read_b64 v[140:141], v39 offset:1600
    v_mfma_f32_16x16x32_bf16 v[212:215], v[80:83], v[100:103], v[212:215]
    ds_read_b64 v[142:143], v39 offset:1608
    v_mfma_f32_16x16x32_bf16 v[216:219], v[72:75], v[112:115], v[216:219]
    ds_read_b128 v[176:179], v38 offset:1600
    v_mfma_f32_16x16x32_bf16 v[216:219], v[80:83], v[104:107], v[216:219]
    ds_read_b64 v[144:145], v39 offset:2112
    v_mfma_f32_16x16x32_bf16 v[220:223], v[76:79], v[112:115], 0
    ds_read_b64 v[146:147], v39 offset:2120
    v_mfma_f32_16x16x32_bf16 v[220:223], v[80:83], v[108:111], v[220:223]
    ds_read_b128 v[180:183], v38 offset:1088
    s_waitcnt lgkmcnt(15)
    v_mfma_f32_16x16x32_bf16 v[212:215], v[64:67], v[116:119], v[212:215]
    ds_read_b64 v[148:149], v39 offset:2624
    v_mfma_f32_16x16x32_bf16 v[212:215], v[84:87], v[96:99], v[212:215]
    ds_read_b64 v[150:151], v39 offset:2632
    v_mfma_f32_16x16x32_bf16 v[216:219], v[68:71], v[116:119], v[216:219]
    ds_read_b128 v[184:187], v38 offset:576
    v_mfma_f32_16x16x32_bf16 v[216:219], v[84:87], v[100:103], v[216:219]
    ds_read_b64 v[152:153], v39 offset:3136
    v_mfma_f32_16x16x32_bf16 v[220:223], v[72:75], v[116:119], v[220:223]
    ds_read_b64 v[154:155], v39 offset:3144
    v_mfma_f32_16x16x32_bf16 v[220:223], v[84:87], v[104:107], v[220:223]
    ds_read_b128 v[188:191], v38 offset:64
    v_mfma_f32_16x16x32_bf16 v[216:219], v[64:67], v[120:123], v[216:219]
    ds_read_b64 v[156:157], v39 offset:3648
    v_mfma_f32_16x16x32_bf16 v[216:219], v[88:91], v[96:99], v[216:219]
    ds_read_b64 v[158:159], v39 offset:3656
    v_mfma_f32_16x16x32_bf16 v[220:223], v[68:71], v[120:123], v[220:223]
    v_mfma_f32_16x16x32_bf16 v[220:223], v[88:91], v[100:103], v[220:223]
    v_mfma_f32_16x16x32_bf16 v[220:223], v[64:67], v[124:127], v[220:223]
    v_mfma_f32_16x16x32_bf16 v[220:223], v[92:95], v[96:99], v[220:223]
    s_waitcnt lgkmcnt(15)
    v_mfma_f32_16x16x32_bf16 v[192:195], v[128:131], v[160:163], v[192:195]
    v_mfma_f32_16x16x32_bf16 v[196:199], v[128:131], v[164:167], v[196:199]
    v_mfma_f32_16x16x32_bf16 v[196:199], v[132:135], v[160:163], v[196:199]
    v_mfma_f32_16x16x32_bf16 v[200:203], v[132:135], v[164:167], v[200:203]
    v_mfma_f32_16x16x32_bf16 v[200:203], v[128:131], v[168:171], v[200:203]
    v_mfma_f32_16x16x32_bf16 v[200:203], v[136:139], v[160:163], v[200:203]
    v_mfma_f32_16x16x32_bf16 v[204:207], v[132:135], v[168:171], v[204:207]
    v_mfma_f32_16x16x32_bf16 v[204:207], v[136:139], v[164:167], v[204:207]
    v_mfma_f32_16x16x32_bf16 v[208:211], v[136:139], v[168:171], v[208:211]
    ds_read_b128 v[96:99], v38 offset:3712
    s_waitcnt lgkmcnt(13)
    v_mfma_f32_16x16x32_bf16 v[204:207], v[128:131], v[172:175], v[204:207]
    ds_read_b64 v[64:65], v39 offset:128
    v_mfma_f32_16x16x32_bf16 v[204:207], v[140:143], v[160:163], v[204:207]
    ds_read_b64 v[66:67], v39 offset:136
    v_mfma_f32_16x16x32_bf16 v[208:211], v[132:135], v[172:175], v[208:211]
    ds_read_b128 v[100:103], v38 offset:3200
    v_mfma_f32_16x16x32_bf16 v[208:211], v[140:143], v[164:167], v[208:211]
    ds_read_b64 v[68:69], v39 offset:640
    v_mfma_f32_16x16x32_bf16 v[212:215], v[136:139], v[172:175], v[212:215]
    ds_read_b64 v[70:71], v39 offset:648
    v_mfma_f32_16x16x32_bf16 v[212:215], v[140:143], v[168:171], v[212:215]
    ds_read_b128 v[104:107], v38 offset:2688
    v_mfma_f32_16x16x32_bf16 v[216:219], v[140:143], v[172:175], v[216:219]
    ds_read_b64 v[72:73], v39 offset:1152
    s_waitcnt lgkmcnt(15)
    v_mfma_f32_16x16x32_bf16 v[208:211], v[128:131], v[176:179], v[208:211]
    ds_read_b64 v[74:75], v39 offset:1160
    v_mfma_f32_16x16x32_bf16 v[208:211], v[144:147], v[160:163], v[208:211]
    ds_read_b128 v[108:111], v38 offset:2176
    v_mfma_f32_16x16x32_bf16 v[212:215], v[132:135], v[176:179], v[212:215]
    ds_read_b64 v[76:77], v39 offset:1664
    v_mfma_f32_16x16x32_bf16 v[212:215], v[144:147], v[164:167], v[212:215]
    ds_read_b64 v[78:79], v39 offset:1672
    v_mfma_f32_16x16x32_bf16 v[216:219], v[136:139], v[176:179], v[216:219]
    ds_read_b128 v[112:115], v38 offset:1664
    v_mfma_f32_16x16x32_bf16 v[216:219], v[144:147], v[168:171], v[216:219]
    ds_read_b64 v[80:81], v39 offset:2176
    v_mfma_f32_16x16x32_bf16 v[220:223], v[140:143], v[176:179], v[220:223]
    ds_read_b64 v[82:83], v39 offset:2184
    v_mfma_f32_16x16x32_bf16 v[220:223], v[144:147], v[172:175], v[220:223]
    ds_read_b128 v[116:119], v38 offset:1152
    s_waitcnt lgkmcnt(15)
    v_mfma_f32_16x16x32_bf16 v[212:215], v[128:131], v[180:183], v[212:215]
    ds_read_b64 v[84:85], v39 offset:2688
    v_mfma_f32_16x16x32_bf16 v[212:215], v[148:151], v[160:163], v[212:215]
    ds_read_b64 v[86:87], v39 offset:2696
    v_mfma_f32_16x16x32_bf16 v[216:219], v[132:135], v[180:183], v[216:219]
    ds_read_b128 v[120:123], v38 offset:640
    v_mfma_f32_16x16x32_bf16 v[216:219], v[148:151], v[164:167], v[216:219]
    ds_read_b64 v[88:89], v39 offset:3200
    v_mfma_f32_16x16x32_bf16 v[220:223], v[136:139], v[180:183], v[220:223]
    ds_read_b64 v[90:91], v39 offset:3208
    v_mfma_f32_16x16x32_bf16 v[220:223], v[148:151], v[168:171], v[220:223]
    ds_read_b128 v[124:127], v38 offset:128
    v_mfma_f32_16x16x32_bf16 v[216:219], v[128:131], v[184:187], v[216:219]
    ds_read_b64 v[92:93], v39 offset:3712
    v_mfma_f32_16x16x32_bf16 v[216:219], v[152:155], v[160:163], v[216:219]
    ds_read_b64 v[94:95], v39 offset:3720
    v_mfma_f32_16x16x32_bf16 v[220:223], v[132:135], v[184:187], v[220:223]
    v_mfma_f32_16x16x32_bf16 v[220:223], v[152:155], v[164:167], v[220:223]
    v_mfma_f32_16x16x32_bf16 v[220:223], v[128:131], v[188:191], v[220:223]
    v_mfma_f32_16x16x32_bf16 v[220:223], v[156:159], v[160:163], v[220:223]
    s_waitcnt lgkmcnt(15)
    v_mfma_f32_16x16x32_bf16 v[192:195], v[64:67], v[96:99], v[192:195]
    v_mfma_f32_16x16x32_bf16 v[196:199], v[64:67], v[100:103], v[196:199]
    v_mfma_f32_16x16x32_bf16 v[196:199], v[68:71], v[96:99], v[196:199]
    v_mfma_f32_16x16x32_bf16 v[200:203], v[68:71], v[100:103], v[200:203]
    v_mfma_f32_16x16x32_bf16 v[200:203], v[64:67], v[104:107], v[200:203]
    v_mfma_f32_16x16x32_bf16 v[200:203], v[72:75], v[96:99], v[200:203]
    v_mfma_f32_16x16x32_bf16 v[204:207], v[68:71], v[104:107], v[204:207]
    v_mfma_f32_16x16x32_bf16 v[204:207], v[72:75], v[100:103], v[204:207]
    v_mfma_f32_16x16x32_bf16 v[208:211], v[72:75], v[104:107], v[208:211]
    ds_read_b128 v[160:163], v38 offset:3776
    s_waitcnt lgkmcnt(13)
    v_mfma_f32_16x16x32_bf16 v[204:207], v[64:67], v[108:111], v[204:207]
    ds_read_b64 v[128:129], v39 offset:192
    v_mfma_f32_16x16x32_bf16 v[204:207], v[76:79], v[96:99], v[204:207]
    ds_read_b64 v[130:131], v39 offset:200
    v_mfma_f32_16x16x32_bf16 v[208:211], v[68:71], v[108:111], v[208:211]
    ds_read_b128 v[164:167], v38 offset:3264
    v_mfma_f32_16x16x32_bf16 v[208:211], v[76:79], v[100:103], v[208:211]
    ds_read_b64 v[132:133], v39 offset:704
    v_mfma_f32_16x16x32_bf16 v[212:215], v[72:75], v[108:111], v[212:215]
    ds_read_b64 v[134:135], v39 offset:712
    v_mfma_f32_16x16x32_bf16 v[212:215], v[76:79], v[104:107], v[212:215]
    ds_read_b128 v[168:171], v38 offset:2752
    v_mfma_f32_16x16x32_bf16 v[216:219], v[76:79], v[108:111], v[216:219]
    ds_read_b64 v[136:137], v39 offset:1216
    s_waitcnt lgkmcnt(15)
    v_mfma_f32_16x16x32_bf16 v[208:211], v[64:67], v[112:115], v[208:211]
    ds_read_b64 v[138:139], v39 offset:1224
    v_mfma_f32_16x16x32_bf16 v[208:211], v[80:83], v[96:99], v[208:211]
    ds_read_b128 v[172:175], v38 offset:2240
    v_mfma_f32_16x16x32_bf16 v[212:215], v[68:71], v[112:115], v[212:215]
    ds_read_b64 v[140:141], v39 offset:1728
    v_mfma_f32_16x16x32_bf16 v[212:215], v[80:83], v[100:103], v[212:215]
    ds_read_b64 v[142:143], v39 offset:1736
    v_mfma_f32_16x16x32_bf16 v[216:219], v[72:75], v[112:115], v[216:219]
    ds_read_b128 v[176:179], v38 offset:1728
    v_mfma_f32_16x16x32_bf16 v[216:219], v[80:83], v[104:107], v[216:219]
    ds_read_b64 v[144:145], v39 offset:2240
    v_mfma_f32_16x16x32_bf16 v[220:223], v[76:79], v[112:115], v[220:223]
    ds_read_b64 v[146:147], v39 offset:2248
    v_mfma_f32_16x16x32_bf16 v[220:223], v[80:83], v[108:111], v[220:223]
    ds_read_b128 v[180:183], v38 offset:1216
    s_waitcnt lgkmcnt(15)
    v_mfma_f32_16x16x32_bf16 v[212:215], v[64:67], v[116:119], v[212:215]
    ds_read_b64 v[148:149], v39 offset:2752
    v_mfma_f32_16x16x32_bf16 v[212:215], v[84:87], v[96:99], v[212:215]
    ds_read_b64 v[150:151], v39 offset:2760
    v_mfma_f32_16x16x32_bf16 v[216:219], v[68:71], v[116:119], v[216:219]
    ds_read_b128 v[184:187], v38 offset:704
    v_mfma_f32_16x16x32_bf16 v[216:219], v[84:87], v[100:103], v[216:219]
    ds_read_b64 v[152:153], v39 offset:3264
    v_mfma_f32_16x16x32_bf16 v[220:223], v[72:75], v[116:119], v[220:223]
    ds_read_b64 v[154:155], v39 offset:3272
    v_mfma_f32_16x16x32_bf16 v[220:223], v[84:87], v[104:107], v[220:223]
    ds_read_b128 v[188:191], v38 offset:192
    v_mfma_f32_16x16x32_bf16 v[216:219], v[64:67], v[120:123], v[216:219]
    ds_read_b64 v[156:157], v39 offset:3776
    v_mfma_f32_16x16x32_bf16 v[216:219], v[88:91], v[96:99], v[216:219]
    ds_read_b64 v[158:159], v39 offset:3784
    v_mfma_f32_16x16x32_bf16 v[220:223], v[68:71], v[120:123], v[220:223]
    v_mfma_f32_16x16x32_bf16 v[220:223], v[88:91], v[100:103], v[220:223]
    v_mfma_f32_16x16x32_bf16 v[220:223], v[64:67], v[124:127], v[220:223]
    v_mfma_f32_16x16x32_bf16 v[220:223], v[92:95], v[96:99], v[220:223]
    s_waitcnt lgkmcnt(15)
    v_mfma_f32_16x16x32_bf16 v[192:195], v[128:131], v[160:163], v[192:195]
    v_mfma_f32_16x16x32_bf16 v[196:199], v[128:131], v[164:167], v[196:199]
    v_mfma_f32_16x16x32_bf16 v[196:199], v[132:135], v[160:163], v[196:199]
    v_mfma_f32_16x16x32_bf16 v[200:203], v[132:135], v[164:167], v[200:203]
    v_mfma_f32_16x16x32_bf16 v[200:203], v[128:131], v[168:171], v[200:203]
    v_mfma_f32_16x16x32_bf16 v[200:203], v[136:139], v[160:163], v[200:203]
    v_mfma_f32_16x16x32_bf16 v[204:207], v[132:135], v[168:171], v[204:207]
    v_mfma_f32_16x16x32_bf16 v[204:207], v[136:139], v[164:167], v[204:207]
    v_mfma_f32_16x16x32_bf16 v[208:211], v[136:139], v[168:171], v[208:211]
    s_waitcnt lgkmcnt(12)
    v_mfma_f32_16x16x32_bf16 v[204:207], v[128:131], v[172:175], v[204:207]
    v_mfma_f32_16x16x32_bf16 v[204:207], v[140:143], v[160:163], v[204:207]
    v_mfma_f32_16x16x32_bf16 v[208:211], v[132:135], v[172:175], v[208:211]
    v_mfma_f32_16x16x32_bf16 v[208:211], v[140:143], v[164:167], v[208:211]
    v_mfma_f32_16x16x32_bf16 v[212:215], v[136:139], v[172:175], v[212:215]
    v_mfma_f32_16x16x32_bf16 v[212:215], v[140:143], v[168:171], v[212:215]
    v_mfma_f32_16x16x32_bf16 v[216:219], v[140:143], v[172:175], v[216:219]
    s_waitcnt lgkmcnt(9)
    v_mfma_f32_16x16x32_bf16 v[208:211], v[128:131], v[176:179], v[208:211]
    v_mfma_f32_16x16x32_bf16 v[208:211], v[144:147], v[160:163], v[208:211]
    v_mfma_f32_16x16x32_bf16 v[212:215], v[132:135], v[176:179], v[212:215]
    v_mfma_f32_16x16x32_bf16 v[212:215], v[144:147], v[164:167], v[212:215]
    v_mfma_f32_16x16x32_bf16 v[216:219], v[136:139], v[176:179], v[216:219]
    v_mfma_f32_16x16x32_bf16 v[216:219], v[144:147], v[168:171], v[216:219]
    v_mfma_f32_16x16x32_bf16 v[220:223], v[140:143], v[176:179], v[220:223]
    v_mfma_f32_16x16x32_bf16 v[220:223], v[144:147], v[172:175], v[220:223]
    s_waitcnt lgkmcnt(6)
    v_mfma_f32_16x16x32_bf16 v[212:215], v[128:131], v[180:183], v[212:215]
    v_mfma_f32_16x16x32_bf16 v[212:215], v[148:151], v[160:163], v[212:215]
    v_mfma_f32_16x16x32_bf16 v[216:219], v[132:135], v[180:183], v[216:219]
    v_mfma_f32_16x16x32_bf16 v[216:219], v[148:151], v[164:167], v[216:219]
    v_mfma_f32_16x16x32_bf16 v[220:223], v[136:139], v[180:183], v[220:223]
    v_mfma_f32_16x16x32_bf16 v[220:223], v[148:151], v[168:171], v[220:223]
    s_waitcnt lgkmcnt(3)
    v_mfma_f32_16x16x32_bf16 v[216:219], v[128:131], v[184:187], v[216:219]
    v_mfma_f32_16x16x32_bf16 v[216:219], v[152:155], v[160:163], v[216:219]
    v_mfma_f32_16x16x32_bf16 v[220:223], v[132:135], v[184:187], v[220:223]
    v_mfma_f32_16x16x32_bf16 v[220:223], v[152:155], v[164:167], v[220:223]
    s_waitcnt lgkmcnt(0)
    v_mfma_f32_16x16x32_bf16 v[220:223], v[128:131], v[188:191], v[220:223]
    v_mfma_f32_16x16x32_bf16 v[220:223], v[156:159], v[160:163], v[220:223]
    s_setprio 3
    s_nop 7
    s_cmp_eq_u32 s98, 0
    s_cbranch_scc0 NOSWAP_29
    v_swap_b32 v192, v208
    v_swap_b32 v193, v209
    v_swap_b32 v194, v210
    v_swap_b32 v195, v211
    v_swap_b32 v196, v212
    v_swap_b32 v197, v213
    v_swap_b32 v198, v214
    v_swap_b32 v199, v215
    v_swap_b32 v200, v216
    v_swap_b32 v201, v217
    v_swap_b32 v202, v218
    v_swap_b32 v203, v219
    v_swap_b32 v204, v220
    v_swap_b32 v205, v221
    v_swap_b32 v206, v222
    v_swap_b32 v207, v223
NOSWAP_29:
    ds_write_b128 v20, v[192:195] offset:0
    ds_write_b128 v20, v[196:199] offset:1024
    ds_write_b128 v20, v[200:203] offset:2048
    ds_write_b128 v20, v[204:207] offset:3072
    ds_read_b128 v[64:67], v22 offset:1536
    ds_read_b128 v[68:71], v22 offset:1024
    ds_read_b128 v[72:75], v22 offset:512
    ds_read_b128 v[76:79], v22 offset:0
    v_lshlrev_b32 v224, 16, v224
    v_cmp_eq_u32 vcc, 1, v36
    v_mov_b32 v32, 2
    s_waitcnt lgkmcnt(0)
    ds_write_b32 v33, v32
    s_movk_i32 s101, 32767
SLP_31:
    ds_read_b32 v31, v34
    s_waitcnt lgkmcnt(0)
    v_readfirstlane_b32 s70, v31
    s_nop 0
    s_cmp_ge_u32 s70, 2
    s_cbranch_scc1 SOK_30
    s_sleep 1
    s_sub_u32 s101, s101, 1
    s_cbranch_scc0 SLP_31
SOK_30:
    ds_read_b128 v[80:83], v21 offset:0
    ds_read_b128 v[84:87], v21 offset:1024
    ds_read_b128 v[88:91], v21 offset:2048
    ds_read_b128 v[92:95], v21 offset:3072
    s_waitcnt lgkmcnt(0)
    v_add_f32 v208, v208, v80
    v_lshlrev_b32 v96, 16, v67
    v_add_f32 v209, v209, v81
    v_lshlrev_b32 v97, 16, v66
    v_add_f32 v210, v210, v82
    v_lshlrev_b32 v98, 16, v65
    v_add_f32 v211, v211, v83
    v_lshlrev_b32 v99, 16, v64
    v_fmac_f32 v208, v224, v96
    v_fmac_f32 v209, v224, v97
    v_fmac_f32 v210, v224, v98
    v_fmac_f32 v211, v224, v99
    v_cvt_pk_bf16_f32 v100, v208, v209
    v_cvt_pk_bf16_f32 v101, v210, v211
    v_cndmask_b32 v102, v101, v100, vcc
    v_cndmask_b32 v103, v100, v101, vcc
    s_nop 0
    v_mov_b32_dpp v104, v102 quad_perm:[1,0,3,2] row_mask:0xf bank_mask:0xf
    v_perm_b32 v106, v104, v103, v24
    v_perm_b32 v107, v104, v103, v25
    ds_write_b64 v28, v[106:107] offset:0
    v_add_f32 v212, v212, v84
    v_lshlrev_b32 v96, 16, v71
    v_add_f32 v213, v213, v85
    v_lshlrev_b32 v97, 16, v70
    v_add_f32 v214, v214, v86
    v_lshlrev_b32 v98, 16, v69
    v_add_f32 v215, v215, v87
    v_lshlrev_b32 v99, 16, v68
    v_fmac_f32 v212, v224, v96
    v_fmac_f32 v213, v224, v97
    v_fmac_f32 v214, v224, v98
    v_fmac_f32 v215, v224, v99
    v_cvt_pk_bf16_f32 v100, v212, v213
    v_cvt_pk_bf16_f32 v101, v214, v215
    v_cndmask_b32 v102, v101, v100, vcc
    v_cndmask_b32 v103, v100, v101, vcc
    s_nop 0
    v_mov_b32_dpp v104, v102 quad_perm:[1,0,3,2] row_mask:0xf bank_mask:0xf
    v_perm_b32 v108, v104, v103, v24
    v_perm_b32 v109, v104, v103, v25
    ds_write_b64 v28, v[108:109] offset:512
    v_add_f32 v216, v216, v88
    v_lshlrev_b32 v96, 16, v75
    v_add_f32 v217, v217, v89
    v_lshlrev_b32 v97, 16, v74
    v_add_f32 v218, v218, v90
    v_lshlrev_b32 v98, 16, v73
    v_add_f32 v219, v219, v91
    v_lshlrev_b32 v99, 16, v72
    v_fmac_f32 v216, v224, v96
    v_fmac_f32 v217, v224, v97
    v_fmac_f32 v218, v224, v98
    v_fmac_f32 v219, v224, v99
    v_cvt_pk_bf16_f32 v100, v216, v217
    v_cvt_pk_bf16_f32 v101, v218, v219
    v_cndmask_b32 v102, v101, v100, vcc
    v_cndmask_b32 v103, v100, v101, vcc
    s_nop 0
    v_mov_b32_dpp v104, v102 quad_perm:[1,0,3,2] row_mask:0xf bank_mask:0xf
    v_perm_b32 v110, v104, v103, v24
    v_perm_b32 v111, v104, v103, v25
    ds_write_b64 v28, v[110:111] offset:1024
    v_add_f32 v220, v220, v92
    v_lshlrev_b32 v96, 16, v79
    v_add_f32 v221, v221, v93
    v_lshlrev_b32 v97, 16, v78
    v_add_f32 v222, v222, v94
    v_lshlrev_b32 v98, 16, v77
    v_add_f32 v223, v223, v95
    v_lshlrev_b32 v99, 16, v76
    v_fmac_f32 v220, v224, v96
    v_fmac_f32 v221, v224, v97
    v_fmac_f32 v222, v224, v98
    v_fmac_f32 v223, v224, v99
    v_cvt_pk_bf16_f32 v100, v220, v221
    v_cvt_pk_bf16_f32 v101, v222, v223
    v_cndmask_b32 v102, v101, v100, vcc
    v_cndmask_b32 v103, v100, v101, vcc
    s_nop 0
    v_mov_b32_dpp v104, v102 quad_perm:[1,0,3,2] row_mask:0xf bank_mask:0xf
    v_perm_b32 v112, v104, v103, v24
    v_perm_b32 v113, v104, v103, v25
    ds_write_b64 v28, v[112:113] offset:1536
    ds_read_b128 v[44:47], v21
    ds_read_b128 v[48:51], v21 offset:1024
    s_waitcnt lgkmcnt(0)
    buffer_store_dwordx4 v[44:47], v225, s[60:63], 0 offen sc1
    buffer_store_dwordx4 v[48:51], v225, s[60:63], 0 offen offset:1024 sc1
    s_waitcnt vmcnt(0)
    buffer_store_dword v12, v10, s[48:51], s18 offen sc1
    s_endpgm
.p2align 6
L_G:
    s_setprio 2
    s_sub_u32 s92, s28, 4
    s_lshl_b32 s70, s64, 1
    s_add_u32 s68, s70, s67
    s_lshl_b32 s69, s69, 1
    s_add_u32 s70, s65, 14
    s_cmp_eq_u32 s92, 0
    s_cselect_b32 s70, s65, s70
    s_cmp_lt_u32 s92, 2
    s_cselect_b32 s70, s70, 16
    s_lshl_b32 s71, s64, 4
    s_add_u32 s71, s71, s70
    v_lshrrev_b32 v20, 3, v0
    v_and_b32 v21, 7, v0
    s_mul_i32 s29, s31, 9363
    s_lshr_b32 s29, s29, 16
    s_mul_i32 s72, s29, 7
    s_sub_u32 s30, s31, s72
    s_lshl_b32 s72, s30, 9
    s_lshl_b32 s73, s92, 7
    s_add_u32 s72, s72, s73
    v_and_b32 v27, 15, v0
    v_lshlrev_b32 v28, 3, v27
    v_mov_b32 v100, 0x7fffffff
    v_mul_u32_u24 v22, 896, v20
    v_lshl_add_u32 v22, v21, 4, v22
    s_mul_i32 s74, s71, 8*896
    s_waitcnt lgkmcnt(0)
    s_mov_b32 s36, s10
    s_mov_b32 s37, s11
    s_mov_b32 s38, 3584
    s_mov_b32 s39, 0x20000
    s_mov_b32 s32, s4
    s_mov_b32 s33, s5
    s_mov_b32 s34, 1835008
    s_mov_b32 s35, 0x20000
    buffer_load_dwordx2 v[108:109], v28, s[36:39], s72 offen
    s_cmp_lt_u32 s70, 16
    s_cbranch_scc0 NOSTAT_32
    buffer_load_dwordx4 v[64:67], v22, s[32:35], s74 offen offset:0
    buffer_load_dwordx4 v[68:71], v22, s[32:35], s74 offen offset:128
    buffer_load_dwordx4 v[72:75], v22, s[32:35], s74 offen offset:256
    buffer_load_dwordx4 v[76:79], v22, s[32:35], s74 offen offset:384
    buffer_load_dwordx4 v[80:83], v22, s[32:35], s74 offen offset:512
    buffer_load_dwordx4 v[84:87], v22, s[32:35], s74 offen offset:640
    buffer_load_dwordx4 v[88:91], v22, s[32:35], s74 offen offset:768
NOSTAT_32:
    s_lshl_b32 s71, s71, 6
    s_add_u32 s93, s71, 65536
    s_mov_b32 s94, s70
    v_lshlrev_b32 v9, 4, v0
    v_cmp_eq_u32 vcc, 0, v0
    v_mov_b32 v10, 0x7fffffff
    s_nop 0
    v_cndmask_b32 v10, v10, 0, vcc
    v_mov_b32 v11, 0
    v_and_b32 v14, 31, v0
    v_lshrrev_b32 v15, 5, v0
    v_bfe_u32 v28, v0, 1, 3
    v_xor_b32 v28, v28, v15
    s_and_b32 s70, s28, 1
    s_lshl_b32 s70, s70, 13
    v_lshlrev_b32 v29, 7, v14
    v_lshl_add_u32 v28, v28, 4, v29
    v_add_u32 v1, s70, v28
    v_xor_b32 v2, 32, v1
    v_xor_b32 v3, 64, v1
    v_xor_b32 v4, 96, v1
    v_bfe_u32 v28, v0, 2, 2
    v_bfe_u32 v29, v0, 4, 1
    v_and_b32 v7, 3, v0
    v_lshlrev_b32 v30, 6, v28
    v_lshl_add_u32 v30, v29, 5, v30
    v_lshl_add_u32 v30, v7, 3, v30
    v_lshl_add_u32 v13, v15, 8, v30
    v_lshl_add_u32 v30, v15, 9, v30
    s_lshr_b32 s70, s92, 1
    s_lshl_b32 s70, s70, 13
    s_add_u32 s70, s70, 16384
    v_add_u32 v5, s70, v30
    v_add_u32 v58, 0x10000, v1
    v_add_u32 v59, 0x10000, v2
    v_add_u32 v60, 0x10000, v3
    v_add_u32 v61, 0x10000, v4
    v_add_u32 v62, 0x10000, v5
    v_lshlrev_b32 v63, 3, v14
    v_lshrrev_b32 v6, 2, v0
    v_mul_u32_u24 v8, 896, v6
    v_lshl_add_u32 v8, v7, 4, v8
    v_lshlrev_b32 v6, 12, v6
    v_lshl_add_u32 v6, v7, 4, v6
    s_lshl_b32 s95, s92, 13
    v_add_u32 v13, s95, v13
    s_lshr_b32 s71, s92, 1
    s_lshl_b32 s72, s71, 2
    s_and_b32 s73, s28, 1
    s_add_u32 s72, s72, s73
    s_mul_i32 s70, s72, 14336
    s_lshl_b32 s74, s66, 7
    s_add_u32 s70, s70, s74
    s_lshl_b32 s71, s71, 6
    s_add_u32 s99, s70, s71
    s_xor_b32 s75, s71, 64
    s_add_u32 s100, s70, s75
    s_lshl_b32 s70, s68, 1
    s_add_u32 s70, s70, s73
    s_mul_i32 s96, s70, 32*896
    s_add_u32 s96, s96, s74
    s_add_u32 s96, s96, s71
    s_mul_i32 s74, s70, 112
    s_add_u32 s74, s74, s72
    s_lshl_b32 s97, s74, 10
    s_xor_b32 s70, s70, 1
    s_mul_i32 s74, s70, 112
    s_add_u32 s74, s74, s72
    s_lshl_b32 s98, s74, 10
    s_mov_b32 s76, 0xbfb8aa3b
    v_lshrrev_b32 v22, 4, v0
    v_and_b32 v26, 3, v0
    v_lshrrev_b32 v29, 2, v27
    v_lshl_add_u32 v29, v22, 4, v29
    v_lshlrev_b32 v29, 7, v29
    v_lshl_add_u32 v29, v26, 3, v29
    s_lshl_b32 s72, s92, 5
    s_add_u32 s72, s72, 131072
    v_add_u32 v104, s72, v29
    s_mul_i32 s72, s92, 2304
    s_add_u32 s72, s72, 148480
    v_mul_u32_u24 v105, 144, v27
    v_sub_u32 v29, 3, v22
    v_lshl_add_u32 v105, v29, 5, v105
    v_add_u32 v105, s72, v105
    v_mul_u32_u24 v106, 144, v20
    v_lshl_add_u32 v106, v21, 4, v106
    v_add_u32 v106, s72, v106
    v_lshlrev_b32 v107, 12, v20
    v_lshl_add_u32 v107, v21, 4, v107
    s_mov_b32 s36, s26
    s_mov_b32 s37, s27
    s_mov_b32 s38, 1835008
    s_mov_b32 s39, 0x20000
    s_add_u32 s44, s26, 4194304
    s_addc_u32 s45, s27, 0
    s_mov_b32 s46, 7340032
    s_mov_b32 s47, 0x20000
    s_add_u32 s48, s26, 12582912
    s_addc_u32 s49, s27, 0
    s_mov_b32 s50, 196608
    s_mov_b32 s51, 0x20000
    s_mov_b32 s52, s24
    s_mov_b32 s53, s25
    s_mov_b32 s54, 256
    s_mov_b32 s55, 0x20000
    s_mov_b32 s40, s20
    s_mov_b32 s41, s21
    s_mov_b32 s42, 1605632
    s_mov_b32 s43, 0x20000
    s_mov_b32 s56, s22
    s_mov_b32 s57, s23
    s_mov_b32 s58, 1835008
    s_mov_b32 s59, 0x20000
    s_add_u32 s60, s26, 2097152
    s_addc_u32 s61, s27, 0
    s_mov_b32 s62, 1835008
    s_mov_b32 s63, 0x20000
    s_cmp_lt_u32 s94, 16
    s_cbranch_scc0 NOSTAT_33
    s_mov_b32 s73, 0x3f803f80
    v_cmp_eq_u32 vcc, 0, v21
    v_lshlrev_b32 v23, 3, v20
    s_nop 0
    v_cndmask_b32 v100, v100, v23, vcc
    s_waitcnt vmcnt(6)
    v_dot2_f32_bf16 v92, v64, s73, 0
    v_dot2_f32_bf16 v96, v64, v64, 0
    v_dot2_f32_bf16 v93, v65, s73, 0
    v_dot2_f32_bf16 v97, v65, v65, 0
    v_dot2_f32_bf16 v94, v66, s73, 0
    v_dot2_f32_bf16 v98, v66, v66, 0
    v_dot2_f32_bf16 v95, v67, s73, 0
    v_dot2_f32_bf16 v99, v67, v67, 0
    s_waitcnt vmcnt(5)
    v_dot2_f32_bf16 v92, v68, s73, v92
    v_dot2_f32_bf16 v96, v68, v68, v96
    v_dot2_f32_bf16 v93, v69, s73, v93
    v_dot2_f32_bf16 v97, v69, v69, v97
    v_dot2_f32_bf16 v94, v70, s73, v94
    v_dot2_f32_bf16 v98, v70, v70, v98
    v_dot2_f32_bf16 v95, v71, s73, v95
    v_dot2_f32_bf16 v99, v71, v71, v99
    s_waitcnt vmcnt(4)
    v_dot2_f32_bf16 v92, v72, s73, v92
    v_dot2_f32_bf16 v96, v72, v72, v96
    v_dot2_f32_bf16 v93, v73, s73, v93
    v_dot2_f32_bf16 v97, v73, v73, v97
    v_dot2_f32_bf16 v94, v74, s73, v94
    v_dot2_f32_bf16 v98, v74, v74, v98
    v_dot2_f32_bf16 v95, v75, s73, v95
    v_dot2_f32_bf16 v99, v75, v75, v99
    s_waitcnt vmcnt(3)
    v_dot2_f32_bf16 v92, v76, s73, v92
    v_dot2_f32_bf16 v96, v76, v76, v96
    v_dot2_f32_bf16 v93, v77, s73, v93
    v_dot2_f32_bf16 v97, v77, v77, v97
    v_dot2_f32_bf16 v94, v78, s73, v94
    v_dot2_f32_bf16 v98, v78, v78, v98
    v_dot2_f32_bf16 v95, v79, s73, v95
    v_dot2_f32_bf16 v99, v79, v79, v99
    s_waitcnt vmcnt(2)
    v_dot2_f32_bf16 v92, v80, s73, v92
    v_dot2_f32_bf16 v96, v80, v80, v96
    v_dot2_f32_bf16 v93, v81, s73, v93
    v_dot2_f32_bf16 v97, v81, v81, v97
    v_dot2_f32_bf16 v94, v82, s73, v94
    v_dot2_f32_bf16 v98, v82, v82, v98
    v_dot2_f32_bf16 v95, v83, s73, v95
    v_dot2_f32_bf16 v99, v83, v83, v99
    s_waitcnt vmcnt(1)
    v_dot2_f32_bf16 v92, v84, s73, v92
    v_dot2_f32_bf16 v96, v84, v84, v96
    v_dot2_f32_bf16 v93, v85, s73, v93
    v_dot2_f32_bf16 v97, v85, v85, v97
    v_dot2_f32_bf16 v94, v86, s73, v94
    v_dot2_f32_bf16 v98, v86, v86, v98
    v_dot2_f32_bf16 v95, v87, s73, v95
    v_dot2_f32_bf16 v99, v87, v87, v99
    s_waitcnt vmcnt(0)
    v_dot2_f32_bf16 v92, v88, s73, v92
    v_dot2_f32_bf16 v96, v88, v88, v96
    v_dot2_f32_bf16 v93, v89, s73, v93
    v_dot2_f32_bf16 v97, v89, v89, v97
    v_dot2_f32_bf16 v94, v90, s73, v94
    v_dot2_f32_bf16 v98, v90, v90, v98
    v_dot2_f32_bf16 v95, v91, s73, v95
    v_dot2_f32_bf16 v99, v91, v91, v99
    v_add_f32 v92, v92, v93
    v_add_f32 v96, v96, v97
    v_add_f32 v94, v94, v95
    v_add_f32 v98, v98, v99
    v_add_f32 v92, v92, v94
    v_add_f32 v96, v96, v98
    s_nop 0
    v_add_f32_dpp v92, v92, v92 quad_perm:[1,0,3,2] row_mask:0xf bank_mask:0xf
    v_add_f32_dpp v96, v96, v96 quad_perm:[1,0,3,2] row_mask:0xf bank_mask:0xf
    s_nop 0
    v_add_f32_dpp v92, v92, v92 quad_perm:[2,3,0,1] row_mask:0xf bank_mask:0xf
    v_add_f32_dpp v96, v96, v96 quad_perm:[2,3,0,1] row_mask:0xf bank_mask:0xf
    s_nop 0
    v_add_f32_dpp v92, v92, v92 row_half_mirror row_mask:0xf bank_mask:0xf
    v_add_f32_dpp v96, v96, v96 row_half_mirror row_mask:0xf bank_mask:0xf
    v_mul_f32 v92, 0x3b124925, v92
    v_mul_f32 v96, 0x3b124925, v96
    v_fma_f32 v96, -v92, v92, v96
    v_max_f32 v96, 0, v96
    v_cvt_pk_bf16_f32 v96, v96, v96
    v_and_b32 v96, 0xffff0000, v96
    v_add_f32 v96, 0x3727c5ac, v96
    v_cvt_pk_bf16_f32 v96, v96, v96
    v_and_b32 v96, 0xffff0000, v96
    v_sqrt_f32 v96, v96
    s_nop 0
    v_cvt_pk_bf16_f32 v102, v92, v96
NOSTAT_33:
    s_waitcnt vmcnt(0)
    s_barrier
    ds_read_b64_tr_b16 v[64:65], v104 offset:512
    ds_read_b64_tr_b16 v[66:67], v104 offset:1024
    ds_read_b64_tr_b16 v[68:69], v104 offset:1536
    ds_read_b64_tr_b16 v[70:71], v104 offset:2048
    ds_read_b64_tr_b16 v[72:73], v104 offset:2560
    ds_read_b64_tr_b16 v[232:233], v104 offset:9216
    ds_read_b64_tr_b16 v[234:235], v104 offset:9728
    ds_read_b64_tr_b16 v[236:237], v104 offset:10240
    ds_read_b64_tr_b16 v[238:239], v104 offset:10752
    v_alignbit_b32 v224, v109, v109, 16
    v_alignbit_b32 v225, v108, v108, 16
    s_waitcnt lgkmcnt(0)
    v_alignbit_b32 v36, v65, v64, 16
    v_alignbit_b32 v37, v66, v65, 16
    v_alignbit_b32 v38, v67, v66, 16
    v_alignbit_b32 v39, v68, v67, 16
    v_alignbit_b32 v40, v69, v68, 16
    v_alignbit_b32 v41, v70, v69, 16
    v_alignbit_b32 v42, v71, v70, 16
    v_alignbit_b32 v43, v72, v71, 16
    v_alignbit_b32 v44, v73, v72, 16
    v_dot2_f32_bf16 v208, v36, v224, 0
    v_dot2_f32_bf16 v209, v65, v224, 0
    v_dot2_f32_bf16 v210, v37, v224, 0
    v_dot2_f32_bf16 v211, v66, v224, 0
    v_dot2_f32_bf16 v212, v38, v224, 0
    v_dot2_f32_bf16 v213, v67, v224, 0
    v_dot2_f32_bf16 v214, v39, v224, 0
    v_dot2_f32_bf16 v215, v68, v224, 0
    v_dot2_f32_bf16 v216, v40, v224, 0
    v_dot2_f32_bf16 v217, v69, v224, 0
    v_dot2_f32_bf16 v218, v41, v224, 0
    v_dot2_f32_bf16 v219, v70, v224, 0
    v_dot2_f32_bf16 v220, v42, v224, 0
    v_dot2_f32_bf16 v221, v71, v224, 0
    v_dot2_f32_bf16 v222, v43, v224, 0
    v_dot2_f32_bf16 v223, v72, v224, 0
    v_dot2_f32_bf16 v208, v37, v225, v208
    v_dot2_f32_bf16 v209, v66, v225, v209
    v_dot2_f32_bf16 v210, v38, v225, v210
    v_dot2_f32_bf16 v211, v67, v225, v211
    v_dot2_f32_bf16 v212, v39, v225, v212
    v_dot2_f32_bf16 v213, v68, v225, v213
    v_dot2_f32_bf16 v214, v40, v225, v214
    v_dot2_f32_bf16 v215, v69, v225, v215
    v_dot2_f32_bf16 v216, v41, v225, v216
    v_dot2_f32_bf16 v217, v70, v225, v217
    v_dot2_f32_bf16 v218, v42, v225, v218
    v_dot2_f32_bf16 v219, v71, v225, v219
    v_dot2_f32_bf16 v220, v43, v225, v220
    v_dot2_f32_bf16 v221, v72, v225, v221
    v_dot2_f32_bf16 v222, v44, v225, v222
    v_dot2_f32_bf16 v223, v73, v225, v223
    v_lshlrev_b32 v192, 16, v232
    v_and_b32 v193, 0xffff0000, v232
    v_lshlrev_b32 v194, 16, v233
    v_and_b32 v195, 0xffff0000, v233
    v_lshlrev_b32 v196, 16, v234
    v_and_b32 v197, 0xffff0000, v234
    v_lshlrev_b32 v198, 16, v235
    v_and_b32 v199, 0xffff0000, v235
    v_lshlrev_b32 v200, 16, v236
    v_and_b32 v201, 0xffff0000, v236
    v_lshlrev_b32 v202, 16, v237
    v_and_b32 v203, 0xffff0000, v237
    v_lshlrev_b32 v204, 16, v238
    v_and_b32 v205, 0xffff0000, v238
    v_lshlrev_b32 v206, 16, v239
    v_and_b32 v207, 0xffff0000, v239
    v_mul_f32 v208, v208, v192
    v_mul_f32 v209, v209, v193
    v_mul_f32 v210, v210, v194
    v_mul_f32 v211, v211, v195
    v_mul_f32 v212, v212, v196
    v_mul_f32 v213, v213, v197
    v_mul_f32 v214, v214, v198
    v_mul_f32 v215, v215, v199
    v_mul_f32 v216, v216, v200
    v_mul_f32 v217, v217, v201
    v_mul_f32 v218, v218, v202
    v_mul_f32 v219, v219, v203
    v_mul_f32 v220, v220, v204
    v_mul_f32 v221, v221, v205
    v_mul_f32 v222, v222, v206
    v_mul_f32 v223, v223, v207
    v_cvt_pk_bf16_f32 v64, v223, v222
    v_cvt_pk_bf16_f32 v65, v221, v220
    v_cvt_pk_bf16_f32 v66, v219, v218
    v_cvt_pk_bf16_f32 v67, v217, v216
    v_cvt_pk_bf16_f32 v68, v215, v214
    v_cvt_pk_bf16_f32 v69, v213, v212
    v_cvt_pk_bf16_f32 v70, v211, v210
    v_cvt_pk_bf16_f32 v71, v209, v208
    ds_write_b128 v105, v[64:67]
    ds_write_b128 v105, v[68:71] offset:16
    ds_read_b128 v[72:75], v106
    ds_read_b128 v[76:79], v106 offset:1152
    s_lshl_b32 s74, s30, 18
    s_lshl_b32 s75, s92, 16
    s_add_u32 s74, s74, s75
    s_add_u32 s74, s74, 3968
    s_lshl_b32 s75, s29, 7
    s_sub_u32 s74, s74, s75
    s_add_u32 s75, s74, 8*4096
    v_mov_b32 v81, 0
    v_mov_b32 v82, 0
    v_mov_b32 v83, 0
    v_mov_b32 v85, 0
    v_mov_b32 v86, 0
    v_mov_b32 v87, 0
    v_mov_b32 v89, 0
    v_mov_b32 v90, 0
    v_mov_b32 v91, 0
    v_mov_b32 v93, 0
    v_mov_b32 v94, 0
    v_mov_b32 v95, 0
    v_mov_b32 v117, 161792
    v_cmp_eq_u32 vcc, 0, v0
    v_mov_b32 v118, 1
    v_lshlrev_b32 v119, 2, v0
    v_add_u32 v119, 162048, v119
    v_cndmask_b32 v119, v119, v117, vcc
    ds_read_b32 v120, v117 offset:96
    s_waitcnt lgkmcnt(0)
    v_cmp_gt_u32 vcc, 4, v120
    s_cbranch_vccnz LBAD_34
LOK_35:
    ds_read_b64_tr_b16 v[32:33], v5 offset:0
    ds_read_b64_tr_b16 v[34:35], v5 offset:256
    ds_read_b128 v[16:19], v1 offset:0
    ds_read_b64_tr_b16 v[36:37], v5 offset:4096
    ds_read_b64_tr_b16 v[38:39], v5 offset:4352
    ds_read_b128 v[20:23], v1 offset:4096
    ds_read_b64_tr_b16 v[40:41], v5 offset:1024
    ds_read_b64_tr_b16 v[42:43], v5 offset:1280
    ds_read_b128 v[24:27], v2 offset:0
    ds_read_b64_tr_b16 v[44:45], v5 offset:5120
    ds_read_b64_tr_b16 v[46:47], v5 offset:5376
    ds_read_b128 v[28:31], v2 offset:4096
    s_waitcnt lgkmcnt(6)
    v_mfma_f32_32x32x16_bf16 v[128:143], v[32:35], v[16:19], 0
    buffer_load_dword v12, v11, s[52:55], 0 offen sc1
    v_mfma_f32_32x32x16_bf16 v[144:159], v[32:35], v[20:23], 0
    buffer_store_dwordx4 v[72:75], v107, s[36:39], s74 offen sc1
    v_mfma_f32_32x32x16_bf16 v[160:175], v[36:39], v[16:19], 0
    buffer_store_dwordx4 v[76:79], v107, s[36:39], s75 offen sc1
    v_mfma_f32_32x32x16_bf16 v[176:191], v[36:39], v[20:23], 0
    ds_read_b64_tr_b16 v[32:33], v5 offset:2048
    ds_read_b64_tr_b16 v[34:35], v5 offset:2304
    ds_read_b128 v[16:19], v3 offset:0
    ds_read_b64_tr_b16 v[36:37], v5 offset:6144
    ds_read_b64_tr_b16 v[38:39], v5 offset:6400
    ds_read_b128 v[20:23], v3 offset:4096
    s_waitcnt lgkmcnt(6)
    v_mfma_f32_32x32x16_bf16 v[128:143], v[40:43], v[24:27], v[128:143]
    v_mfma_f32_32x32x16_bf16 v[144:159], v[40:43], v[28:31], v[144:159]
    v_mfma_f32_32x32x16_bf16 v[160:175], v[44:47], v[24:27], v[160:175]
    v_mfma_f32_32x32x16_bf16 v[176:191], v[44:47], v[28:31], v[176:191]
    ds_read_b64_tr_b16 v[40:41], v5 offset:3072
    ds_read_b64_tr_b16 v[42:43], v5 offset:3328
    ds_read_b128 v[24:27], v4 offset:0
    ds_read_b64_tr_b16 v[44:45], v5 offset:7168
    ds_read_b64_tr_b16 v[46:47], v5 offset:7424
    ds_read_b128 v[28:31], v4 offset:4096
    ds_read_b32 v120, v117 offset:100
    s_waitcnt lgkmcnt(7)
    v_mfma_f32_32x32x16_bf16 v[128:143], v[32:35], v[16:19], v[128:143]
    v_mfma_f32_32x32x16_bf16 v[144:159], v[32:35], v[20:23], v[144:159]
    v_mfma_f32_32x32x16_bf16 v[160:175], v[36:39], v[16:19], v[160:175]
    v_mfma_f32_32x32x16_bf16 v[176:191], v[36:39], v[20:23], v[176:191]
    s_waitcnt lgkmcnt(1)
    ds_add_u32 v119, v118 offset:128
    s_waitcnt lgkmcnt(1)
    v_cmp_gt_u32 vcc, 4, v120
    s_cbranch_vccnz LBAD_36
LOK_37:
    ds_read_b64_tr_b16 v[32:33], v5 offset:32768
    ds_read_b64_tr_b16 v[34:35], v5 offset:33024
    ds_read_b128 v[16:19], v1 offset:32768
    ds_read_b64_tr_b16 v[36:37], v5 offset:36864
    ds_read_b64_tr_b16 v[38:39], v5 offset:37120
    ds_read_b128 v[20:23], v1 offset:36864
    v_mfma_f32_32x32x16_bf16 v[128:143], v[40:43], v[24:27], v[128:143]
    v_mfma_f32_32x32x16_bf16 v[144:159], v[40:43], v[28:31], v[144:159]
    v_mfma_f32_32x32x16_bf16 v[160:175], v[44:47], v[24:27], v[160:175]
    v_mfma_f32_32x32x16_bf16 v[176:191], v[44:47], v[28:31], v[176:191]
    ds_read_b64_tr_b16 v[40:41], v5 offset:33792
    ds_read_b64_tr_b16 v[42:43], v5 offset:34048
    ds_read_b128 v[24:27], v2 offset:32768
    ds_read_b64_tr_b16 v[44:45], v5 offset:37888
    ds_read_b64_tr_b16 v[46:47], v5 offset:38144
    ds_read_b128 v[28:31], v2 offset:36864
    s_waitcnt lgkmcnt(6)
    v_mfma_f32_32x32x16_bf16 v[128:143], v[32:35], v[16:19], v[128:143]
    v_mfma_f32_32x32x16_bf16 v[144:159], v[32:35], v[20:23], v[144:159]
    v_mfma_f32_32x32x16_bf16 v[160:175], v[36:39], v[16:19], v[160:175]
    v_mfma_f32_32x32x16_bf16 v[176:191], v[36:39], v[20:23], v[176:191]
    ds_read_b64_tr_b16 v[32:33], v5 offset:34816
    ds_read_b64_tr_b16 v[34:35], v5 offset:35072
    ds_read_b128 v[16:19], v3 offset:32768
    ds_read_b64_tr_b16 v[36:37], v5 offset:38912
    ds_read_b64_tr_b16 v[38:39], v5 offset:39168
    ds_read_b128 v[20:23], v3 offset:36864
    s_waitcnt lgkmcnt(6)
    v_mfma_f32_32x32x16_bf16 v[128:143], v[40:43], v[24:27], v[128:143]
    v_mfma_f32_32x32x16_bf16 v[144:159], v[40:43], v[28:31], v[144:159]
    v_mfma_f32_32x32x16_bf16 v[160:175], v[44:47], v[24:27], v[160:175]
    v_mfma_f32_32x32x16_bf16 v[176:191], v[44:47], v[28:31], v[176:191]
    ds_read_b64_tr_b16 v[40:41], v5 offset:35840
    ds_read_b64_tr_b16 v[42:43], v5 offset:36096
    ds_read_b128 v[24:27], v4 offset:32768
    ds_read_b64_tr_b16 v[44:45], v5 offset:39936
    ds_read_b64_tr_b16 v[46:47], v5 offset:40192
    ds_read_b128 v[28:31], v4 offset:36864
    ds_read_b32 v120, v117 offset:104
    s_waitcnt lgkmcnt(7)
    v_mfma_f32_32x32x16_bf16 v[128:143], v[32:35], v[16:19], v[128:143]
    v_mfma_f32_32x32x16_bf16 v[144:159], v[32:35], v[20:23], v[144:159]
    v_mfma_f32_32x32x16_bf16 v[160:175], v[36:39], v[16:19], v[160:175]
    v_mfma_f32_32x32x16_bf16 v[176:191], v[36:39], v[20:23], v[176:191]
    s_waitcnt lgkmcnt(1)
    ds_add_u32 v119, v118 offset:132
    s_waitcnt lgkmcnt(1)
    v_cmp_gt_u32 vcc, 4, v120
    s_cbranch_vccnz LBAD_38
LOK_39:
    ds_read_b64_tr_b16 v[32:33], v62 offset:0
    ds_read_b64_tr_b16 v[34:35], v62 offset:256
    ds_read_b128 v[16:19], v58 offset:0
    ds_read_b64_tr_b16 v[36:37], v62 offset:4096
    ds_read_b64_tr_b16 v[38:39], v62 offset:4352
    ds_read_b128 v[20:23], v58 offset:4096
    v_mfma_f32_32x32x16_bf16 v[128:143], v[40:43], v[24:27], v[128:143]
    v_mfma_f32_32x32x16_bf16 v[144:159], v[40:43], v[28:31], v[144:159]
    v_mfma_f32_32x32x16_bf16 v[160:175], v[44:47], v[24:27], v[160:175]
    v_mfma_f32_32x32x16_bf16 v[176:191], v[44:47], v[28:31], v[176:191]
    ds_read_b64_tr_b16 v[40:41], v62 offset:1024
    ds_read_b64_tr_b16 v[42:43], v62 offset:1280
    ds_read_b128 v[24:27], v59 offset:0
    ds_read_b64_tr_b16 v[44:45], v62 offset:5120
    ds_read_b64_tr_b16 v[46:47], v62 offset:5376
    ds_read_b128 v[28:31], v59 offset:4096
    s_waitcnt lgkmcnt(6)
    v_mfma_f32_32x32x16_bf16 v[128:143], v[32:35], v[16:19], v[128:143]
    s_waitcnt vmcnt(2)
    s_movk_i32 s101, 32767
LP_41:
    v_readfirstlane_b32 s77, v12
    s_nop 1
    s_cmp_lg_u32 s77, 0
    s_cbranch_scc1 OK_40
    s_sub_u32 s101, s101, 1
    s_cbranch_scc1 OK_40
    s_sleep 1
    buffer_load_dword v12, v11, s[52:55], 0 offen sc1
    s_waitcnt vmcnt(0)
    s_branch LP_41
OK_40:
    v_mov_b32 v12, s77
    v_mov_b32 v103, s77
    buffer_store_dwordx2 v[102:103], v100, s[48:51], s93 offen
    s_getreg_b32 s19, hwreg(HW_REG_XCC_ID)
    s_lshl_b32 s70, s64, 7
    s_lshl_b32 s71, s65, 3
    s_and_b32 s19, s19, 15
    s_add_u32 s70, s70, s71
    v_mov_b32 v114, s19
    v_mov_b32 v115, s77
    s_add_u32 s70, s70, 32768
    buffer_store_dwordx2 v[114:115], v10, s[48:51], s70 offen
    v_mfma_f32_32x32x16_bf16 v[144:159], v[32:35], v[20:23], v[144:159]
    v_mfma_f32_32x32x16_bf16 v[160:175], v[36:39], v[16:19], v[160:175]
    v_mfma_f32_32x32x16_bf16 v[176:191], v[36:39], v[20:23], v[176:191]
    ds_read_b64_tr_b16 v[32:33], v62 offset:2048
    ds_read_b64_tr_b16 v[34:35], v62 offset:2304
    ds_read_b128 v[16:19], v60 offset:0
    ds_read_b64_tr_b16 v[36:37], v62 offset:6144
    ds_read_b64_tr_b16 v[38:39], v62 offset:6400
    ds_read_b128 v[20:23], v60 offset:4096
    s_waitcnt lgkmcnt(6)
    v_mfma_f32_32x32x16_bf16 v[128:143], v[40:43], v[24:27], v[128:143]
    s_lshl_b32 s72, s30, 2
    s_add_u32 s72, s72, s92
    s_lshl_b32 s72, s72, 7
    s_lshl_b32 s73, s29, 2
    s_add_u32 s72, s72, s73
    s_waitcnt vmcnt(2)
    buffer_store_dword v12, v10, s[48:51], s72 offen sc1
    v_mfma_f32_32x32x16_bf16 v[144:159], v[40:43], v[28:31], v[144:159]
    v_mfma_f32_32x32x16_bf16 v[160:175], v[44:47], v[24:27], v[160:175]
    v_mfma_f32_32x32x16_bf16 v[176:191], v[44:47], v[28:31], v[176:191]
    ds_read_b64_tr_b16 v[40:41], v62 offset:3072
    ds_read_b64_tr_b16 v[42:43], v62 offset:3328
    ds_read_b128 v[24:27], v61 offset:0
    ds_read_b64_tr_b16 v[44:45], v62 offset:7168
    ds_read_b64_tr_b16 v[46:47], v62 offset:7424
    ds_read_b128 v[28:31], v61 offset:4096
    ds_read_b32 v120, v117 offset:108
    s_waitcnt lgkmcnt(7)
    v_mfma_f32_32x32x16_bf16 v[128:143], v[32:35], v[16:19], v[128:143]
    v_mfma_f32_32x32x16_bf16 v[144:159], v[32:35], v[20:23], v[144:159]
    v_mfma_f32_32x32x16_bf16 v[160:175], v[36:39], v[16:19], v[160:175]
    v_mfma_f32_32x32x16_bf16 v[176:191], v[36:39], v[20:23], v[176:191]
    s_waitcnt lgkmcnt(1)
    ds_add_u32 v119, v118 offset:136
    s_waitcnt lgkmcnt(1)
    v_cmp_gt_u32 vcc, 4, v120
    s_cbranch_vccnz LBAD_42
LOK_43:
    ds_read_b64_tr_b16 v[32:33], v62 offset:32768
    ds_read_b64_tr_b16 v[34:35], v62 offset:33024
    ds_read_b128 v[16:19], v58 offset:32768
    ds_read_b64_tr_b16 v[36:37], v62 offset:36864
    ds_read_b64_tr_b16 v[38:39], v62 offset:37120
    ds_read_b128 v[20:23], v58 offset:36864
    v_mfma_f32_32x32x16_bf16 v[128:143], v[40:43], v[24:27], v[128:143]
    v_mfma_f32_32x32x16_bf16 v[144:159], v[40:43], v[28:31], v[144:159]
    v_mfma_f32_32x32x16_bf16 v[160:175], v[44:47], v[24:27], v[160:175]
    v_mfma_f32_32x32x16_bf16 v[176:191], v[44:47], v[28:31], v[176:191]
    ds_read_b64_tr_b16 v[40:41], v62 offset:33792
    ds_read_b64_tr_b16 v[42:43], v62 offset:34048
    ds_read_b128 v[24:27], v59 offset:32768
    ds_read_b64_tr_b16 v[44:45], v62 offset:37888
    ds_read_b64_tr_b16 v[46:47], v62 offset:38144
    ds_read_b128 v[28:31], v59 offset:36864
    s_waitcnt lgkmcnt(6)
    v_mfma_f32_32x32x16_bf16 v[128:143], v[32:35], v[16:19], v[128:143]
    v_mfma_f32_32x32x16_bf16 v[144:159], v[32:35], v[20:23], v[144:159]
    v_mfma_f32_32x32x16_bf16 v[160:175], v[36:39], v[16:19], v[160:175]
    v_mfma_f32_32x32x16_bf16 v[176:191], v[36:39], v[20:23], v[176:191]
    ds_read_b64_tr_b16 v[32:33], v62 offset:34816
    ds_read_b64_tr_b16 v[34:35], v62 offset:35072
    ds_read_b128 v[16:19], v60 offset:32768
    ds_read_b64_tr_b16 v[36:37], v62 offset:38912
    ds_read_b64_tr_b16 v[38:39], v62 offset:39168
    ds_read_b128 v[20:23], v60 offset:36864
    s_waitcnt lgkmcnt(6)
    v_mfma_f32_32x32x16_bf16 v[128:143], v[40:43], v[24:27], v[128:143]
    v_mfma_f32_32x32x16_bf16 v[144:159], v[40:43], v[28:31], v[144:159]
    v_mfma_f32_32x32x16_bf16 v[160:175], v[44:47], v[24:27], v[160:175]
    v_mfma_f32_32x32x16_bf16 v[176:191], v[44:47], v[28:31], v[176:191]
    ds_read_b64_tr_b16 v[40:41], v62 offset:35840
    ds_read_b64_tr_b16 v[42:43], v62 offset:36096
    ds_read_b128 v[24:27], v61 offset:32768
    ds_read_b64_tr_b16 v[44:45], v62 offset:39936
    ds_read_b64_tr_b16 v[46:47], v62 offset:40192
    ds_read_b128 v[28:31], v61 offset:36864
    ds_read_b32 v120, v117 offset:112
    s_waitcnt lgkmcnt(7)
    v_mfma_f32_32x32x16_bf16 v[128:143], v[32:35], v[16:19], v[128:143]
    v_mfma_f32_32x32x16_bf16 v[144:159], v[32:35], v[20:23], v[144:159]
    v_mfma_f32_32x32x16_bf16 v[160:175], v[36:39], v[16:19], v[160:175]
    v_mfma_f32_32x32x16_bf16 v[176:191], v[36:39], v[20:23], v[176:191]
    s_waitcnt lgkmcnt(1)
    ds_add_u32 v119, v118 offset:140
    s_waitcnt lgkmcnt(1)
    v_cmp_gt_u32 vcc, 4, v120
    s_cbranch_vccnz LBAD_44
LOK_45:
    ds_read_b64_tr_b16 v[32:33], v5 offset:0
    ds_read_b64_tr_b16 v[34:35], v5 offset:256
    ds_read_b128 v[16:19], v1 offset:0
    ds_read_b64_tr_b16 v[36:37], v5 offset:4096
    ds_read_b64_tr_b16 v[38:39], v5 offset:4352
    ds_read_b128 v[20:23], v1 offset:4096
    v_mfma_f32_32x32x16_bf16 v[128:143], v[40:43], v[24:27], v[128:143]
    v_mfma_f32_32x32x16_bf16 v[144:159], v[40:43], v[28:31], v[144:159]
    v_mfma_f32_32x32x16_bf16 v[160:175], v[44:47], v[24:27], v[160:175]
    v_mfma_f32_32x32x16_bf16 v[176:191], v[44:47], v[28:31], v[176:191]
    ds_read_b64_tr_b16 v[40:41], v5 offset:1024
    ds_read_b64_tr_b16 v[42:43], v5 offset:1280
    ds_read_b128 v[24:27], v2 offset:0
    ds_read_b64_tr_b16 v[44:45], v5 offset:5120
    ds_read_b64_tr_b16 v[46:47], v5 offset:5376
    ds_read_b128 v[28:31], v2 offset:4096
    s_waitcnt lgkmcnt(6)
    v_mfma_f32_32x32x16_bf16 v[128:143], v[32:35], v[16:19], v[128:143]
    v_mfma_f32_32x32x16_bf16 v[144:159], v[32:35], v[20:23], v[144:159]
    v_mfma_f32_32x32x16_bf16 v[160:175], v[36:39], v[16:19], v[160:175]
    v_mfma_f32_32x32x16_bf16 v[176:191], v[36:39], v[20:23], v[176:191]
    ds_read_b64_tr_b16 v[32:33], v5 offset:2048
    ds_read_b64_tr_b16 v[34:35], v5 offset:2304
    ds_read_b128 v[16:19], v3 offset:0
    ds_read_b64_tr_b16 v[36:37], v5 offset:6144
    ds_read_b64_tr_b16 v[38:39], v5 offset:6400
    ds_read_b128 v[20:23], v3 offset:4096
    s_waitcnt lgkmcnt(6)
    v_mfma_f32_32x32x16_bf16 v[128:143], v[40:43], v[24:27], v[128:143]
    v_mfma_f32_32x32x16_bf16 v[144:159], v[40:43], v[28:31], v[144:159]
    v_mfma_f32_32x32x16_bf16 v[160:175], v[44:47], v[24:27], v[160:175]
    v_mfma_f32_32x32x16_bf16 v[176:191], v[44:47], v[28:31], v[176:191]
    ds_read_b64_tr_b16 v[40:41], v5 offset:3072
    ds_read_b64_tr_b16 v[42:43], v5 offset:3328
    ds_read_b128 v[24:27], v4 offset:0
    ds_read_b64_tr_b16 v[44:45], v5 offset:7168
    ds_read_b64_tr_b16 v[46:47], v5 offset:7424
    ds_read_b128 v[28:31], v4 offset:4096
    ds_read_b32 v120, v117 offset:116
    s_waitcnt lgkmcnt(7)
    v_mfma_f32_32x32x16_bf16 v[128:143], v[32:35], v[16:19], v[128:143]
    v_mfma_f32_32x32x16_bf16 v[144:159], v[32:35], v[20:23], v[144:159]
    v_mfma_f32_32x32x16_bf16 v[160:175], v[36:39], v[16:19], v[160:175]
    v_mfma_f32_32x32x16_bf16 v[176:191], v[36:39], v[20:23], v[176:191]
    s_waitcnt lgkmcnt(1)
    ds_add_u32 v119, v118 offset:144
    s_waitcnt lgkmcnt(1)
    v_cmp_gt_u32 vcc, 4, v120
    s_cbranch_vccnz LBAD_46
LOK_47:
    ds_read_b64_tr_b16 v[32:33], v5 offset:32768
    ds_read_b64_tr_b16 v[34:35], v5 offset:33024
    ds_read_b128 v[16:19], v1 offset:32768
    ds_read_b64_tr_b16 v[36:37], v5 offset:36864
    ds_read_b64_tr_b16 v[38:39], v5 offset:37120
    ds_read_b128 v[20:23], v1 offset:36864
    v_mfma_f32_32x32x16_bf16 v[128:143], v[40:43], v[24:27], v[128:143]
    v_mfma_f32_32x32x16_bf16 v[144:159], v[40:43], v[28:31], v[144:159]
    v_mfma_f32_32x32x16_bf16 v[160:175], v[44:47], v[24:27], v[160:175]
    v_mfma_f32_32x32x16_bf16 v[176:191], v[44:47], v[28:31], v[176:191]
    ds_read_b64_tr_b16 v[40:41], v5 offset:33792
    ds_read_b64_tr_b16 v[42:43], v5 offset:34048
    ds_read_b128 v[24:27], v2 offset:32768
    ds_read_b64_tr_b16 v[44:45], v5 offset:37888
    ds_read_b64_tr_b16 v[46:47], v5 offset:38144
    ds_read_b128 v[28:31], v2 offset:36864
    s_waitcnt lgkmcnt(6)
    v_mfma_f32_32x32x16_bf16 v[128:143], v[32:35], v[16:19], v[128:143]
    s_and_b32 s70, s28, 1
    s_lshl_b32 s74, s70, 9
    s_lshr_b32 s75, s92, 1
    s_lshl_b32 s75, s75, 9
    s_lshl_b32 s73, s67, 9
    s_lshl_b32 s70, s70, 8
    s_add_u32 s73, s73, s70
    s_lshl_b32 s70, s64, 10
    s_add_u32 s70, s70, 65536
    s_add_u32 s74, s74, s70
    s_add_u32 s73, s73, s70
    s_lshl_b32 s70, s65, 10
    s_add_u32 s70, s70, 131072
    s_add_u32 s75, s75, s70
    v_mfma_f32_32x32x16_bf16 v[144:159], v[32:35], v[20:23], v[144:159]
    s_lshl_b32 s70, s64, 1
    s_and_b32 s71, s28, 1
    s_add_u32 s70, s70, s71
    s_mul_i32 s72, s70, 224
    s_lshl_b32 s18, s65, 3
    s_add_u32 s72, s72, s18
    s_lshr_b32 s71, s92, 1
    s_lshl_b32 s18, s71, 2
    s_add_u32 s72, s72, s18
    s_lshl_b32 s16, s72, 10
    s_add_u32 s17, s16, 112*1024
    s_lshl_b32 s70, s70, 1
    s_add_u32 s70, s70, s71
    s_lshl_b32 s70, s70, 7
    s_lshl_b32 s18, s65, 2
    s_add_u32 s18, s18, s70
    s_add_u32 s18, s18, 16384
    v_mfma_f32_32x32x16_bf16 v[160:175], v[36:39], v[16:19], v[160:175]
    v_mfma_f32_32x32x16_bf16 v[176:191], v[36:39], v[20:23], v[176:191]
    ds_read_b64_tr_b16 v[32:33], v5 offset:34816
    ds_read_b64_tr_b16 v[34:35], v5 offset:35072
    ds_read_b128 v[16:19], v3 offset:32768
    ds_read_b64_tr_b16 v[36:37], v5 offset:38912
    ds_read_b64_tr_b16 v[38:39], v5 offset:39168
    ds_read_b128 v[20:23], v3 offset:36864
    s_waitcnt lgkmcnt(6)
    v_mfma_f32_32x32x16_bf16 v[128:143], v[40:43], v[24:27], v[128:143]
    v_mfma_f32_32x32x16_bf16 v[144:159], v[40:43], v[28:31], v[144:159]
    v_mfma_f32_32x32x16_bf16 v[160:175], v[44:47], v[24:27], v[160:175]
    v_mfma_f32_32x32x16_bf16 v[176:191], v[44:47], v[28:31], v[176:191]
    ds_read_b64_tr_b16 v[40:41], v5 offset:35840
    ds_read_b64_tr_b16 v[42:43], v5 offset:36096
    ds_read_b128 v[24:27], v4 offset:32768
    ds_read_b64_tr_b16 v[44:45], v5 offset:39936
    ds_read_b64_tr_b16 v[46:47], v5 offset:40192
    ds_read_b128 v[28:31], v4 offset:36864
    ds_read_b32 v120, v117 offset:120
    s_waitcnt lgkmcnt(7)
    v_mfma_f32_32x32x16_bf16 v[128:143], v[32:35], v[16:19], v[128:143]
    buffer_load_dwordx2 v[232:233], v63, s[48:51], s74 offen sc1
    v_mfma_f32_32x32x16_bf16 v[144:159], v[32:35], v[20:23], v[144:159]
    buffer_load_dwordx2 v[234:235], v63, s[48:51], s74 offen offset:256 sc1
    v_mfma_f32_32x32x16_bf16 v[160:175], v[36:39], v[16:19], v[160:175]
    buffer_load_dwordx2 v[236:237], v63, s[48:51], s75 offen sc1
    v_mfma_f32_32x32x16_bf16 v[176:191], v[36:39], v[20:23], v[176:191]
    s_waitcnt lgkmcnt(1)
    ds_add_u32 v119, v118 offset:148
    s_waitcnt lgkmcnt(1)
    v_cmp_gt_u32 vcc, 4, v120
    s_cbranch_vccnz LBAD_48
LOK_49:
    ds_read_b64_tr_b16 v[32:33], v62 offset:0
    ds_read_b64_tr_b16 v[34:35], v62 offset:256
    ds_read_b128 v[16:19], v58 offset:0
    ds_read_b64_tr_b16 v[36:37], v62 offset:4096
    ds_read_b64_tr_b16 v[38:39], v62 offset:4352
    ds_read_b128 v[20:23], v58 offset:4096
    v_mfma_f32_32x32x16_bf16 v[128:143], v[40:43], v[24:27], v[128:143]
    buffer_load_dwordx2 v[238:239], v63, s[48:51], s75 offen offset:256 sc1
    v_mfma_f32_32x32x16_bf16 v[144:159], v[40:43], v[28:31], v[144:159]
    buffer_load_dwordx2 v[240:241], v63, s[48:51], s73 offen sc1
    v_mfma_f32_32x32x16_bf16 v[160:175], v[44:47], v[24:27], v[160:175]
    v_and_b32 v116, 15, v0
    v_lshlrev_b32 v116, 3, v116
    s_lshl_b32 s70, s64, 7
    s_add_u32 s70, s70, 32768
    buffer_load_dwordx2 v[242:243], v116, s[48:51], s70 offen sc1
    v_mfma_f32_32x32x16_bf16 v[176:191], v[44:47], v[28:31], v[176:191]
    ds_read_b64_tr_b16 v[40:41], v62 offset:1024
    ds_read_b64_tr_b16 v[42:43], v62 offset:1280
    ds_read_b128 v[24:27], v59 offset:0
    ds_read_b64_tr_b16 v[44:45], v62 offset:5120
    ds_read_b64_tr_b16 v[46:47], v62 offset:5376
    ds_read_b128 v[28:31], v59 offset:4096
    s_waitcnt lgkmcnt(6)
    v_mfma_f32_32x32x16_bf16 v[128:143], v[32:35], v[16:19], v[128:143]
    v_mfma_f32_32x32x16_bf16 v[144:159], v[32:35], v[20:23], v[144:159]
    v_mfma_f32_32x32x16_bf16 v[160:175], v[36:39], v[16:19], v[160:175]
    v_mfma_f32_32x32x16_bf16 v[176:191], v[36:39], v[20:23], v[176:191]
    ds_read_b64_tr_b16 v[32:33], v62 offset:2048
    ds_read_b64_tr_b16 v[34:35], v62 offset:2304
    ds_read_b128 v[16:19], v60 offset:0
    ds_read_b64_tr_b16 v[36:37], v62 offset:6144
    ds_read_b64_tr_b16 v[38:39], v62 offset:6400
    ds_read_b128 v[20:23], v60 offset:4096
    s_waitcnt lgkmcnt(6)
    v_mfma_f32_32x32x16_bf16 v[128:143], v[40:43], v[24:27], v[128:143]
    v_mfma_f32_32x32x16_bf16 v[144:159], v[40:43], v[28:31], v[144:159]
    v_mfma_f32_32x32x16_bf16 v[160:175], v[44:47], v[24:27], v[160:175]
    v_mfma_f32_32x32x16_bf16 v[176:191], v[44:47], v[28:31], v[176:191]
    ds_read_b64_tr_b16 v[40:41], v62 offset:3072
    ds_read_b64_tr_b16 v[42:43], v62 offset:3328
    ds_read_b128 v[24:27], v61 offset:0
    ds_read_b64_tr_b16 v[44:45], v62 offset:7168
    ds_read_b64_tr_b16 v[46:47], v62 offset:7424
    ds_read_b128 v[28:31], v61 offset:4096
    s_waitcnt lgkmcnt(6)
    v_mfma_f32_32x32x16_bf16 v[128:143], v[32:35], v[16:19], v[128:143]
    v_mfma_f32_32x32x16_bf16 v[144:159], v[32:35], v[20:23], v[144:159]
    v_mfma_f32_32x32x16_bf16 v[160:175], v[36:39], v[16:19], v[160:175]
    v_mfma_f32_32x32x16_bf16 v[176:191], v[36:39], v[20:23], v[176:191]
    s_waitcnt lgkmcnt(0)
    ds_add_u32 v119, v118 offset:152
    v_mfma_f32_32x32x16_bf16 v[128:143], v[40:43], v[24:27], v[128:143]
    s_lshl_b32 s70, s92, 2
    s_add_u32 s70, s70, 161808
    v_mov_b32 v98, s70
    s_waitcnt vmcnt(0)
    v_cmp_eq_u32 vcc, s77, v243
    v_cmp_eq_u32 s[70:71], s19, v242
    s_nop 1
    s_and_b32 s70, s70, vcc_lo
    s_and_b32 s70, s70, 0x3fff
    s_cmp_eq_u32 s70, 0x3fff
    s_cselect_b32 s19, 1, 0
    s_cbranch_scc1 NEAR_50
    buffer_store_dwordx2 v[102:103], v100, s[48:51], s93 offen sc1
    s_waitcnt vmcnt(0)
NEAR_50:
    s_movk_i32 s101, 32767
LP_52:
    v_xor_b32 v48, s77, v233
    v_xor_b32 v49, s77, v235
    v_xor_b32 v50, s77, v237
    v_xor_b32 v51, s77, v239
    v_xor_b32 v52, s77, v241
    v_or3_b32 v48, v48, v49, v50
    v_or3_b32 v48, v48, v51, v52
    v_cmp_eq_u32 vcc, 0, v48
    s_nop 1
    s_cmp_eq_u64 vcc, -1
    s_cbranch_scc1 OK_51
    s_sub_u32 s101, s101, 1
    s_cbranch_scc1 OK_51
    s_sleep 1
    buffer_load_dwordx2 v[232:233], v63, s[48:51], s74 offen sc1
    buffer_load_dwordx2 v[234:235], v63, s[48:51], s74 offen offset:256 sc1
    buffer_load_dwordx2 v[236:237], v63, s[48:51], s75 offen sc1
    buffer_load_dwordx2 v[238:239], v63, s[48:51], s75 offen offset:256 sc1
    buffer_load_dwordx2 v[240:241], v63, s[48:51], s73 offen sc1
    s_waitcnt vmcnt(0)
    s_branch LP_52
OK_51:
    v_mfma_f32_32x32x16_bf16 v[144:159], v[40:43], v[28:31], v[144:159]
    v_cmp_gt_u32 vcc, 32, v0
    s_mov_b32 s70, 0x01000100
    v_perm_b32 v48, v232, v232, s70
    v_and_b32 v50, 0xffff0000, v232
    v_cndmask_b32 v80, 0, v236, vcc
    v_perm_b32 v49, v234, v234, s70
    v_and_b32 v51, 0xffff0000, v234
    v_cndmask_b32 v84, 0, v238, vcc
    v_xor_b32 v48, 0x80008000, v48
    v_rcp_f32 v50, v50
    v_xor_b32 v49, 0x80008000, v49
    v_rcp_f32 v51, v51
    v_cndmask_b32 v88, 0, v48, vcc
    v_cndmask_b32 v92, 0, v49, vcc
    v_mul_f32 v56, s76, v50
    v_mul_f32 v57, s76, v51
    v_lshlrev_b32 v96, 16, v240
    v_and_b32 v97, 0xffff0000, v240
    v_rcp_f32 v97, v97
    v_mfma_f32_32x32x16_bf16 v[160:175], v[44:47], v[24:27], v[160:175]
    v_mfma_f32_32x32x16_bf16 v[176:191], v[44:47], v[28:31], v[176:191]
    v_mfma_f32_32x32x16_bf16 v[128:143], v[80:83], v[88:91], v[128:143]
    v_mfma_f32_32x32x16_bf16 v[144:159], v[80:83], v[92:95], v[144:159]
    v_mfma_f32_32x32x16_bf16 v[160:175], v[84:87], v[88:91], v[160:175]
    v_mfma_f32_32x32x16_bf16 v[176:191], v[84:87], v[92:95], v[176:191]
    v_add_u32 v5, 0x10000, v13
    v_mov_b32 v2, v98
    v_mov_b32 v3, v96
    v_mov_b32 v4, v97
    s_nop 4
    v_mul_f32 v128, v56, v128
    v_mul_f32 v129, v56, v129
    v_mul_f32 v130, v56, v130
    v_mul_f32 v131, v56, v131
    v_exp_f32 v48, v128
    v_exp_f32 v49, v129
    v_exp_f32 v50, v130
    v_exp_f32 v51, v131
    v_fma_f32 v48, v48, s76, s76
    v_fma_f32 v49, v49, s76, s76
    v_fma_f32 v50, v50, s76, s76
    v_fma_f32 v51, v51, s76, s76
    v_rcp_f32 v48, v48
    v_mul_f32 v132, v56, v132
    v_rcp_f32 v49, v49
    v_mul_f32 v133, v56, v133
    v_rcp_f32 v50, v50
    v_mul_f32 v134, v56, v134
    v_rcp_f32 v51, v51
    v_mul_f32 v135, v56, v135
    v_exp_f32 v52, v132
    v_mul_f32 v128, v128, v48
    v_exp_f32 v53, v133
    v_mul_f32 v129, v129, v49
    v_exp_f32 v54, v134
    v_mul_f32 v130, v130, v50
    v_exp_f32 v55, v135
    v_mul_f32 v131, v131, v51
    v_cvt_pk_bf16_f32 v128, v128, v129
    v_cvt_pk_bf16_f32 v129, v130, v131
    v_fma_f32 v52, v52, s76, s76
    v_fma_f32 v53, v53, s76, s76
    v_fma_f32 v54, v54, s76, s76
    v_fma_f32 v55, v55, s76, s76
    v_rcp_f32 v52, v52
    v_mul_f32 v136, v56, v136
    v_rcp_f32 v53, v53
    v_mul_f32 v137, v56, v137
    v_rcp_f32 v54, v54
    v_mul_f32 v138, v56, v138
    v_rcp_f32 v55, v55
    v_mul_f32 v139, v56, v139
    v_exp_f32 v48, v136
    v_mul_f32 v132, v132, v52
    v_exp_f32 v49, v137
    v_mul_f32 v133, v133, v53
    v_exp_f32 v50, v138
    v_mul_f32 v134, v134, v54
    v_exp_f32 v51, v139
    v_mul_f32 v135, v135, v55
    v_cvt_pk_bf16_f32 v130, v132, v133
    v_cvt_pk_bf16_f32 v131, v134, v135
    buffer_store_dwordx4 v[128:131], v9, s[44:47], s16 offen offset:0
    v_fma_f32 v48, v48, s76, s76
    v_fma_f32 v49, v49, s76, s76
    v_fma_f32 v50, v50, s76, s76
    v_fma_f32 v51, v51, s76, s76
    v_rcp_f32 v48, v48
    v_mul_f32 v140, v56, v140
    v_rcp_f32 v49, v49
    v_mul_f32 v141, v56, v141
    v_rcp_f32 v50, v50
    v_mul_f32 v142, v56, v142
    v_rcp_f32 v51, v51
    v_mul_f32 v143, v56, v143
    v_exp_f32 v52, v140
    v_mul_f32 v136, v136, v48
    v_exp_f32 v53, v141
    v_mul_f32 v137, v137, v49
    v_exp_f32 v54, v142
    v_mul_f32 v138, v138, v50
    v_exp_f32 v55, v143
    v_mul_f32 v139, v139, v51
    v_cvt_pk_bf16_f32 v136, v136, v137
    v_cvt_pk_bf16_f32 v137, v138, v139
    v_fma_f32 v52, v52, s76, s76
    v_fma_f32 v53, v53, s76, s76
    v_fma_f32 v54, v54, s76, s76
    v_fma_f32 v55, v55, s76, s76
    v_rcp_f32 v52, v52
    v_mul_f32 v144, v57, v144
    v_rcp_f32 v53, v53
    v_mul_f32 v145, v57, v145
    v_rcp_f32 v54, v54
    v_mul_f32 v146, v57, v146
    v_rcp_f32 v55, v55
    v_mul_f32 v147, v57, v147
    v_exp_f32 v48, v144
    v_mul_f32 v140, v140, v52
    v_exp_f32 v49, v145
    v_mul_f32 v141, v141, v53
    v_exp_f32 v50, v146
    v_mul_f32 v142, v142, v54
    v_exp_f32 v51, v147
    v_mul_f32 v143, v143, v55
    v_cvt_pk_bf16_f32 v138, v140, v141
    v_cvt_pk_bf16_f32 v139, v142, v143
    buffer_store_dwordx4 v[136:139], v9, s[44:47], s16 offen offset:1024
    v_fma_f32 v48, v48, s76, s76
    v_fma_f32 v49, v49, s76, s76
    v_fma_f32 v50, v50, s76, s76
    v_fma_f32 v51, v51, s76, s76
    v_rcp_f32 v48, v48
    v_mul_f32 v148, v57, v148
    v_rcp_f32 v49, v49
    v_mul_f32 v149, v57, v149
    v_rcp_f32 v50, v50
    v_mul_f32 v150, v57, v150
    v_rcp_f32 v51, v51
    v_mul_f32 v151, v57, v151
    v_exp_f32 v52, v148
    v_mul_f32 v144, v144, v48
    v_exp_f32 v53, v149
    v_mul_f32 v145, v145, v49
    v_exp_f32 v54, v150
    v_mul_f32 v146, v146, v50
    v_exp_f32 v55, v151
    v_mul_f32 v147, v147, v51
    v_cvt_pk_bf16_f32 v144, v144, v145
    v_cvt_pk_bf16_f32 v145, v146, v147
    v_fma_f32 v52, v52, s76, s76
    v_fma_f32 v53, v53, s76, s76
    v_fma_f32 v54, v54, s76, s76
    v_fma_f32 v55, v55, s76, s76
    v_rcp_f32 v52, v52
    v_mul_f32 v152, v57, v152
    v_rcp_f32 v53, v53
    v_mul_f32 v153, v57, v153
    v_rcp_f32 v54, v54
    v_mul_f32 v154, v57, v154
    v_rcp_f32 v55, v55
    v_mul_f32 v155, v57, v155
    v_exp_f32 v48, v152
    v_mul_f32 v148, v148, v52
    v_exp_f32 v49, v153
    v_mul_f32 v149, v149, v53
    v_exp_f32 v50, v154
    v_mul_f32 v150, v150, v54
    v_exp_f32 v51, v155
    v_mul_f32 v151, v151, v55
    v_cvt_pk_bf16_f32 v146, v148, v149
    v_cvt_pk_bf16_f32 v147, v150, v151
    buffer_store_dwordx4 v[144:147], v9, s[44:47], s17 offen offset:0
    v_fma_f32 v48, v48, s76, s76
    v_fma_f32 v49, v49, s76, s76
    v_fma_f32 v50, v50, s76, s76
    v_fma_f32 v51, v51, s76, s76
    v_rcp_f32 v48, v48
    v_mul_f32 v156, v57, v156
    v_rcp_f32 v49, v49
    v_mul_f32 v157, v57, v157
    v_rcp_f32 v50, v50
    v_mul_f32 v158, v57, v158
    v_rcp_f32 v51, v51
    v_mul_f32 v159, v57, v159
    v_exp_f32 v52, v156
    v_mul_f32 v152, v152, v48
    v_exp_f32 v53, v157
    v_mul_f32 v153, v153, v49
    v_exp_f32 v54, v158
    v_mul_f32 v154, v154, v50
    v_exp_f32 v55, v159
    v_mul_f32 v155, v155, v51
    v_cvt_pk_bf16_f32 v152, v152, v153
    v_cvt_pk_bf16_f32 v153, v154, v155
    v_fma_f32 v52, v52, s76, s76
    v_fma_f32 v53, v53, s76, s76
    v_fma_f32 v54, v54, s76, s76
    v_fma_f32 v55, v55, s76, s76
    v_rcp_f32 v52, v52
    v_mul_f32 v160, v56, v160
    v_rcp_f32 v53, v53
    v_mul_f32 v161, v56, v161
    v_rcp_f32 v54, v54
    v_mul_f32 v162, v56, v162
    v_rcp_f32 v55, v55
    v_mul_f32 v163, v56, v163
    v_exp_f32 v48, v160
    v_mul_f32 v156, v156, v52
    v_exp_f32 v49, v161
    v_mul_f32 v157, v157, v53
    v_exp_f32 v50, v162
    v_mul_f32 v158, v158, v54
    v_exp_f32 v51, v163
    v_mul_f32 v159, v159, v55
    v_cvt_pk_bf16_f32 v154, v156, v157
    v_cvt_pk_bf16_f32 v155, v158, v159
    buffer_store_dwordx4 v[152:155], v9, s[44:47], s17 offen offset:1024
    v_fma_f32 v48, v48, s76, s76
    v_fma_f32 v49, v49, s76, s76
    v_fma_f32 v50, v50, s76, s76
    v_fma_f32 v51, v51, s76, s76
    v_rcp_f32 v48, v48
    v_mul_f32 v164, v56, v164
    v_rcp_f32 v49, v49
    v_mul_f32 v165, v56, v165
    v_rcp_f32 v50, v50
    v_mul_f32 v166, v56, v166
    v_rcp_f32 v51, v51
    v_mul_f32 v167, v56, v167
    v_exp_f32 v52, v164
    v_mul_f32 v160, v160, v48
    v_exp_f32 v53, v165
    v_mul_f32 v161, v161, v49
    v_exp_f32 v54, v166
    v_mul_f32 v162, v162, v50
    v_exp_f32 v55, v167
    v_mul_f32 v163, v163, v51
    v_cvt_pk_bf16_f32 v160, v160, v161
    v_cvt_pk_bf16_f32 v161, v162, v163
    v_fma_f32 v52, v52, s76, s76
    v_fma_f32 v53, v53, s76, s76
    v_fma_f32 v54, v54, s76, s76
    v_fma_f32 v55, v55, s76, s76
    v_rcp_f32 v52, v52
    v_mul_f32 v168, v56, v168
    v_rcp_f32 v53, v53
    v_mul_f32 v169, v56, v169
    v_rcp_f32 v54, v54
    v_mul_f32 v170, v56, v170
    v_rcp_f32 v55, v55
    v_mul_f32 v171, v56, v171
    v_exp_f32 v48, v168
    v_mul_f32 v164, v164, v52
    v_exp_f32 v49, v169
    v_mul_f32 v165, v165, v53
    v_exp_f32 v50, v170
    v_mul_f32 v166, v166, v54
    v_exp_f32 v51, v171
    v_mul_f32 v167, v167, v55
    v_cvt_pk_bf16_f32 v162, v164, v165
    v_cvt_pk_bf16_f32 v163, v166, v167
    buffer_store_dwordx4 v[160:163], v9, s[44:47], s16 offen offset:2048
    v_fma_f32 v48, v48, s76, s76
    v_fma_f32 v49, v49, s76, s76
    v_fma_f32 v50, v50, s76, s76
    v_fma_f32 v51, v51, s76, s76
    v_rcp_f32 v48, v48
    v_mul_f32 v172, v56, v172
    v_rcp_f32 v49, v49
    v_mul_f32 v173, v56, v173
    v_rcp_f32 v50, v50
    v_mul_f32 v174, v56, v174
    v_rcp_f32 v51, v51
    v_mul_f32 v175, v56, v175
    s_movk_i32 s101, 32767
WLP_54:
    ds_read_b32 v11, v2 offset:48
    s_waitcnt lgkmcnt(0)
    v_readfirstlane_b32 s70, v11
    s_nop 0
    s_cmp_lg_u32 s70, 0
    s_cbranch_scc1 WOK_53
    s_sleep 1
    s_sub_u32 s101, s101, 1
    s_cbranch_scc0 WLP_54
WOK_53:
    ds_read_b64_tr_b16 v[80:81], v13 offset:0
    ds_read_b64_tr_b16 v[82:83], v13 offset:512
    ds_read_b64_tr_b16 v[84:85], v13 offset:1024
    ds_read_b64_tr_b16 v[86:87], v13 offset:1536
    ds_read_b64_tr_b16 v[88:89], v13 offset:2048
    ds_read_b64_tr_b16 v[90:91], v13 offset:2560
    ds_read_b64_tr_b16 v[92:93], v13 offset:3072
    ds_read_b64_tr_b16 v[94:95], v13 offset:3584
    ds_read_b64_tr_b16 v[96:97], v13 offset:4096
    ds_read_b64_tr_b16 v[98:99], v13 offset:4608
    ds_read_b64_tr_b16 v[100:101], v13 offset:5120
    ds_read_b64_tr_b16 v[102:103], v13 offset:5632
    ds_read_b64_tr_b16 v[104:105], v13 offset:6144
    ds_read_b64_tr_b16 v[106:107], v13 offset:6656
    ds_read_b64_tr_b16 v[108:109], v13 offset:7168
    ds_read_b64_tr_b16 v[110:111], v13 offset:7680
    ds_read_b64_tr_b16 v[112:113], v13 offset:32768
    ds_read_b64_tr_b16 v[114:115], v13 offset:33280
    ds_read_b64_tr_b16 v[116:117], v13 offset:33792
    ds_read_b64_tr_b16 v[118:119], v13 offset:34304
    ds_read_b64_tr_b16 v[120:121], v13 offset:34816
    ds_read_b64_tr_b16 v[122:123], v13 offset:35328
    ds_read_b64_tr_b16 v[124:125], v13 offset:35840
    ds_read_b64_tr_b16 v[126:127], v13 offset:36352
    ds_read_b64_tr_b16 v[192:193], v13 offset:36864
    ds_read_b64_tr_b16 v[194:195], v13 offset:37376
    ds_read_b64_tr_b16 v[196:197], v13 offset:37888
    ds_read_b64_tr_b16 v[198:199], v13 offset:38400
    ds_read_b64_tr_b16 v[200:201], v13 offset:38912
    ds_read_b64_tr_b16 v[202:203], v13 offset:39424
    ds_read_b64_tr_b16 v[204:205], v13 offset:39936
    ds_read_b64_tr_b16 v[206:207], v13 offset:40448
    ds_read_b64_tr_b16 v[208:209], v5 offset:0
    ds_read_b64_tr_b16 v[210:211], v5 offset:512
    ds_read_b64_tr_b16 v[212:213], v5 offset:1024
    ds_read_b64_tr_b16 v[214:215], v5 offset:1536
    ds_read_b64_tr_b16 v[216:217], v5 offset:2048
    ds_read_b64_tr_b16 v[218:219], v5 offset:2560
    ds_read_b64_tr_b16 v[220:221], v5 offset:3072
    ds_read_b64_tr_b16 v[222:223], v5 offset:3584
    ds_read_b64_tr_b16 v[224:225], v5 offset:4096
    ds_read_b64_tr_b16 v[226:227], v5 offset:4608
    ds_read_b64_tr_b16 v[228:229], v5 offset:5120
    ds_read_b64_tr_b16 v[230:231], v5 offset:5632
    v_exp_f32 v52, v172
    v_mul_f32 v168, v168, v48
    v_exp_f32 v53, v173
    v_mul_f32 v169, v169, v49
    v_exp_f32 v54, v174
    v_mul_f32 v170, v170, v50
    v_exp_f32 v55, v175
    v_mul_f32 v171, v171, v51
    v_cvt_pk_bf16_f32 v168, v168, v169
    v_cvt_pk_bf16_f32 v169, v170, v171
    v_fma_f32 v52, v52, s76, s76
    v_fma_f32 v53, v53, s76, s76
    v_fma_f32 v54, v54, s76, s76
    v_fma_f32 v55, v55, s76, s76
    v_rcp_f32 v52, v52
    v_mul_f32 v176, v57, v176
    v_rcp_f32 v53, v53
    v_mul_f32 v177, v57, v177
    v_rcp_f32 v54, v54
    v_mul_f32 v178, v57, v178
    v_rcp_f32 v55, v55
    v_mul_f32 v179, v57, v179
    v_exp_f32 v48, v176
    v_mul_f32 v172, v172, v52
    v_exp_f32 v49, v177
    v_mul_f32 v173, v173, v53
    v_exp_f32 v50, v178
    v_mul_f32 v174, v174, v54
    v_exp_f32 v51, v179
    v_mul_f32 v175, v175, v55
    v_cvt_pk_bf16_f32 v170, v172, v173
    v_cvt_pk_bf16_f32 v171, v174, v175
    buffer_store_dwordx4 v[168:171], v9, s[44:47], s16 offen offset:3072
    v_fma_f32 v48, v48, s76, s76
    v_fma_f32 v49, v49, s76, s76
    v_fma_f32 v50, v50, s76, s76
    v_fma_f32 v51, v51, s76, s76
    v_rcp_f32 v48, v48
    v_mul_f32 v180, v57, v180
    v_rcp_f32 v49, v49
    v_mul_f32 v181, v57, v181
    v_rcp_f32 v50, v50
    v_mul_f32 v182, v57, v182
    v_rcp_f32 v51, v51
    v_mul_f32 v183, v57, v183
    v_exp_f32 v52, v180
    v_mul_f32 v176, v176, v48
    v_exp_f32 v53, v181
    v_mul_f32 v177, v177, v49
    v_exp_f32 v54, v182
    v_mul_f32 v178, v178, v50
    v_exp_f32 v55, v183
    v_mul_f32 v179, v179, v51
    v_cvt_pk_bf16_f32 v176, v176, v177
    v_cvt_pk_bf16_f32 v177, v178, v179
    v_fma_f32 v52, v52, s76, s76
    v_fma_f32 v53, v53, s76, s76
    v_fma_f32 v54, v54, s76, s76
    v_fma_f32 v55, v55, s76, s76
    v_rcp_f32 v52, v52
    v_mul_f32 v184, v57, v184
    v_rcp_f32 v53, v53
    v_mul_f32 v185, v57, v185
    v_rcp_f32 v54, v54
    v_mul_f32 v186, v57, v186
    v_rcp_f32 v55, v55
    v_mul_f32 v187, v57, v187
    v_exp_f32 v48, v184
    v_mul_f32 v180, v180, v52
    v_exp_f32 v49, v185
    v_mul_f32 v181, v181, v53
    v_exp_f32 v50, v186
    v_mul_f32 v182, v182, v54
    v_exp_f32 v51, v187
    v_mul_f32 v183, v183, v55
    v_cvt_pk_bf16_f32 v178, v180, v181
    v_cvt_pk_bf16_f32 v179, v182, v183
    buffer_store_dwordx4 v[176:179], v9, s[44:47], s17 offen offset:2048
    v_fma_f32 v48, v48, s76, s76
    v_fma_f32 v49, v49, s76, s76
    v_fma_f32 v50, v50, s76, s76
    v_fma_f32 v51, v51, s76, s76
    v_rcp_f32 v48, v48
    v_mul_f32 v188, v57, v188
    v_rcp_f32 v49, v49
    v_mul_f32 v189, v57, v189
    v_rcp_f32 v50, v50
    v_mul_f32 v190, v57, v190
    v_rcp_f32 v51, v51
    v_mul_f32 v191, v57, v191
    v_exp_f32 v52, v188
    v_mul_f32 v184, v184, v48
    v_exp_f32 v53, v189
    v_mul_f32 v185, v185, v49
    v_exp_f32 v54, v190
    v_mul_f32 v186, v186, v50
    v_exp_f32 v55, v191
    v_mul_f32 v187, v187, v51
    v_cvt_pk_bf16_f32 v184, v184, v185
    v_cvt_pk_bf16_f32 v185, v186, v187
    v_fma_f32 v52, v52, s76, s76
    v_fma_f32 v53, v53, s76, s76
    v_fma_f32 v54, v54, s76, s76
    v_fma_f32 v55, v55, s76, s76
    v_rcp_f32 v52, v52
    v_rcp_f32 v53, v53
    v_rcp_f32 v54, v54
    v_rcp_f32 v55, v55
    s_waitcnt vmcnt(3)
    s_cmp_eq_u32 s19, 1
    s_cbranch_scc0 FAR_55
    buffer_store_dword v12, v10, s[48:51], s18 offen offset:0
FLG_56:
    v_mul_f32 v188, v188, v52
    v_mul_f32 v189, v189, v53
    v_mul_f32 v190, v190, v54
    v_mul_f32 v191, v191, v55
    v_cvt_pk_bf16_f32 v186, v188, v189
    v_cvt_pk_bf16_f32 v187, v190, v191
    buffer_store_dwordx4 v[184:187], v9, s[44:47], s17 offen offset:3072
    v_and_b32 v7, 15, v0
    v_lshlrev_b32 v7, 2, v7
    s_lshl_b32 s74, s68, 1
    s_lshr_b32 s70, s92, 1
    s_add_u32 s74, s74, s70
    s_lshl_b32 s74, s74, 7
    s_add_u32 s74, s74, 16384
    s_lshl_b32 s70, s92, 2
    s_add_u32 s70, s70, 161824
    s_mov_b32 s94, s70
    s_add_u32 m0, s95, 71680
    s_add_u32 s70, s96, 16*896
    buffer_load_dwordx4 v8, s[32:35], s96 offen lds
    s_add_u32 m0, s95, 72704
    s_nop 0
    buffer_load_dwordx4 v8, s[32:35], s70 offen lds
    s_waitcnt lgkmcnt(15)
    s_add_u32 s94, s69, 11
    s_sub_u32 s72, s94, 14
    s_cselect_b32 s94, s94, s72
    s_mul_i32 s94, s94, 114688
    s_add_u32 m0, s95, 0
    s_add_u32 s70, s94, s99
    buffer_load_dwordx4 v8, s[40:43], s70 offen lds
    s_add_u32 m0, s95, 1024
    s_add_u32 s70, s94, s100
    buffer_load_dwordx4 v8, s[40:43], s70 offen lds
    s_add_u32 s94, s69, 12
    s_sub_u32 s72, s94, 14
    s_cselect_b32 s94, s94, s72
    s_mul_i32 s94, s94, 114688
    s_add_u32 m0, s95, 2048
    s_add_u32 s70, s94, s99
    buffer_load_dwordx4 v8, s[40:43], s70 offen lds
    s_add_u32 m0, s95, 3072
    s_add_u32 s70, s94, s100
    buffer_load_dwordx4 v8, s[40:43], s70 offen lds
    s_add_u32 s94, s69, 13
    s_sub_u32 s72, s94, 14
    s_cselect_b32 s94, s94, s72
    s_mul_i32 s94, s94, 114688
    s_add_u32 m0, s95, 4096
    s_add_u32 s70, s94, s99
    buffer_load_dwordx4 v8, s[40:43], s70 offen lds
    s_add_u32 m0, s95, 5120
    s_add_u32 s70, s94, s100
    buffer_load_dwordx4 v8, s[40:43], s70 offen lds
    s_waitcnt vmcnt(8)
    s_cmp_eq_u32 s19, 1
    s_cbranch_scc0 FAR_57
    buffer_store_dword v12, v10, s[48:51], s18 offen offset:64
FLG_58:
    s_add_u32 s94, s69, 0
    s_sub_u32 s72, s94, 14
    s_cselect_b32 s94, s94, s72
    s_mul_i32 s94, s94, 114688
    s_add_u32 s94, s94, 28672
    s_add_u32 m0, s95, 6144
    s_add_u32 s70, s94, s99
    buffer_load_dwordx4 v8, s[40:43], s70 offen lds
    s_add_u32 m0, s95, 7168
    s_add_u32 s70, s94, s100
    buffer_load_dwordx4 v8, s[40:43], s70 offen lds
    s_add_u32 s94, s69, 1
    s_sub_u32 s72, s94, 14
    s_cselect_b32 s94, s94, s72
    s_mul_i32 s94, s94, 114688
    s_add_u32 s94, s94, 28672
    s_add_u32 m0, s95, 32768
    s_add_u32 s70, s94, s99
    buffer_load_dwordx4 v8, s[40:43], s70 offen lds
    s_add_u32 m0, s95, 33792
    s_add_u32 s70, s94, s100
    buffer_load_dwordx4 v8, s[40:43], s70 offen lds
    s_add_u32 s94, s69, 2
    s_sub_u32 s72, s94, 14
    s_cselect_b32 s94, s94, s72
    s_mul_i32 s94, s94, 114688
    s_add_u32 s94, s94, 28672
    s_add_u32 m0, s95, 34816
    s_add_u32 s70, s94, s99
    buffer_load_dwordx4 v8, s[40:43], s70 offen lds
    s_add_u32 m0, s95, 35840
    s_add_u32 s70, s94, s100
    buffer_load_dwordx4 v8, s[40:43], s70 offen lds
    s_add_u32 s94, s69, 3
    s_sub_u32 s72, s94, 14
    s_cselect_b32 s94, s94, s72
    s_mul_i32 s94, s94, 114688
    s_add_u32 s94, s94, 28672
    s_add_u32 m0, s95, 36864
    s_add_u32 s70, s94, s99
    buffer_load_dwordx4 v8, s[40:43], s70 offen lds
    s_add_u32 m0, s95, 37888
    s_add_u32 s70, s94, s100
    buffer_load_dwordx4 v8, s[40:43], s70 offen lds
    s_waitcnt lgkmcnt(12)
    s_add_u32 s94, s69, 4
    s_sub_u32 s72, s94, 14
    s_cselect_b32 s94, s94, s72
    s_mul_i32 s94, s94, 114688
    s_add_u32 s94, s94, 28672
    s_add_u32 m0, s95, 38912
    s_add_u32 s70, s94, s99
    buffer_load_dwordx4 v8, s[40:43], s70 offen lds
    s_add_u32 m0, s95, 39936
    s_add_u32 s70, s94, s100
    buffer_load_dwordx4 v8, s[40:43], s70 offen lds
    s_waitcnt lgkmcnt(8)
    s_add_u32 s94, s69, 5
    s_sub_u32 s72, s94, 14
    s_cselect_b32 s94, s94, s72
    s_mul_i32 s94, s94, 114688
    s_add_u32 s94, s94, 28672
    s_add_u32 m0, s95, 65536
    s_add_u32 s70, s94, s99
    buffer_load_dwordx4 v8, s[40:43], s70 offen lds
    s_add_u32 m0, s95, 66560
    s_add_u32 s70, s94, s100
    buffer_load_dwordx4 v8, s[40:43], s70 offen lds
    s_waitcnt lgkmcnt(4)
    s_add_u32 s94, s69, 6
    s_sub_u32 s72, s94, 14
    s_cselect_b32 s94, s94, s72
    s_mul_i32 s94, s94, 114688
    s_add_u32 s94, s94, 28672
    s_add_u32 m0, s95, 67584
    s_add_u32 s70, s94, s99
    buffer_load_dwordx4 v8, s[40:43], s70 offen lds
    s_add_u32 m0, s95, 68608
    s_add_u32 s70, s94, s100
    buffer_load_dwordx4 v8, s[40:43], s70 offen lds
    s_waitcnt lgkmcnt(0)
    s_add_u32 s94, s69, 7
    s_sub_u32 s72, s94, 14
    s_cselect_b32 s94, s94, s72
    s_mul_i32 s94, s94, 114688
    s_add_u32 s94, s94, 28672
    s_add_u32 m0, s95, 69632
    s_add_u32 s70, s94, s99
    buffer_load_dwordx4 v8, s[40:43], s70 offen lds
    s_add_u32 m0, s95, 70656
    s_add_u32 s70, s94, s100
    buffer_load_dwordx4 v8, s[40:43], s70 offen lds
    buffer_load_dword v1, v7, s[48:51], s74 offen sc1
    v_lshlrev_b32 v2, 6, v14
    v_lshl_add_u32 v2, v15, 3, v2
    v_add_u32 v2, s95, v2
    v_add_u32 v2, 0x10000, v2
    s_waitcnt vmcnt(24)
    ds_read_b64 v[248:249], v2 offset:6144
    ds_read_b64 v[250:251], v2 offset:6160
    ds_read_b64 v[252:253], v2 offset:6176
    ds_read_b64 v[254:255], v2 offset:6192
    s_lshl_b32 s70, s66, 1
    s_lshr_b32 s71, s92, 1
    s_add_u32 s70, s70, s71
    s_lshl_b32 s75, s70, 17
    s_lshl_b32 s70, s70, 1
    s_lshr_b32 s71, s68, 4
    s_add_u32 s70, s70, s71
    s_lshl_b32 s73, s70, 7
    s_add_u32 s73, s73, 8192
    s_lshl_b32 s70, s68, 7
    s_add_u32 s75, s75, s70
    s_and_b32 s71, s28, 1
    s_lshl_b32 s71, s71, 6
    s_add_u32 s75, s75, s71
    v_add_u32 v2, s95, v9
    s_min_u32 s72, s97, s98
    s_sub_u32 s70, s97, s72
    v_add_u32 v10, s70, v9
    s_sub_u32 s70, s98, s72
    v_add_u32 v11, s70, v9
    s_mov_b32 s97, s72
    s_lshl_b32 s70, s69, 13
    s_add_u32 s4, s70, s97
    s_add_u32 s71, s97, 114688
    s_add_u32 s5, s4, 8192
    s_cmp_eq_u32 s5, s71
    s_cselect_b32 s5, s97, s5
    s_add_u32 s6, s5, 8192
    s_cmp_eq_u32 s6, s71
    s_cselect_b32 s6, s97, s6
    s_add_u32 s7, s6, 8192
    s_cmp_eq_u32 s7, s71
    s_cselect_b32 s7, s97, s7
    s_add_u32 s8, s7, 8192
    s_cmp_eq_u32 s8, s71
    s_cselect_b32 s8, s97, s8
    s_add_u32 s9, s8, 8192
    s_cmp_eq_u32 s9, s71
    s_cselect_b32 s9, s97, s9
    s_add_u32 s10, s9, 8192
    s_cmp_eq_u32 s10, s71
    s_cselect_b32 s10, s97, s10
    s_add_u32 s11, s10, 8192
    s_cmp_eq_u32 s11, s71
    s_cselect_b32 s11, s97, s11
    s_add_u32 s12, s11, 8192
    s_cmp_eq_u32 s12, s71
    s_cselect_b32 s12, s97, s12
    s_add_u32 s13, s12, 8192
    s_cmp_eq_u32 s13, s71
    s_cselect_b32 s13, s97, s13
    s_add_u32 s14, s13, 8192
    s_cmp_eq_u32 s14, s71
    s_cselect_b32 s14, s97, s14
    s_add_u32 s15, s14, 8192
    s_cmp_eq_u32 s15, s71
    s_cselect_b32 s15, s97, s15
    s_add_u32 s20, s15, 8192
    s_cmp_eq_u32 s20, s71
    s_cselect_b32 s20, s97, s20
    s_add_u32 s21, s20, 8192
    s_cmp_eq_u32 s21, s71
    s_cselect_b32 s21, s97, s21
    s_waitcnt vmcnt(0)
    s_movk_i32 s101, 32767
LP_60:
    v_cmp_eq_u32 vcc, s77, v1
    s_nop 1
    s_and_b32 vcc_lo, vcc_lo, 16383
    s_cmp_eq_u32 vcc_lo, 16383
    s_cbranch_scc1 OK_59
    s_sub_u32 s101, s101, 1
    s_cbranch_scc1 OK_59
    s_sleep 1
    buffer_load_dword v1, v7, s[48:51], s74 offen sc1
    s_waitcnt vmcnt(0)
    s_branch LP_60
OK_59:
    buffer_load_dwordx4 v[16:19], v10, s[44:47], s4 offen offset:0 sc1
    buffer_load_dwordx4 v[20:23], v11, s[44:47], s4 offen offset:0 sc1
    buffer_load_dwordx4 v[24:27], v10, s[44:47], s5 offen offset:0 sc1
    buffer_load_dwordx4 v[28:31], v11, s[44:47], s5 offen offset:0 sc1
    buffer_load_dwordx4 v[32:35], v10, s[44:47], s6 offen offset:0 sc1
    buffer_load_dwordx4 v[36:39], v11, s[44:47], s6 offen offset:0 sc1
    s_add_u32 s74, s74, 64
    buffer_load_dword v1, v7, s[48:51], s74 offen sc1
    s_waitcnt vmcnt(5)
    v_mfma_f32_32x32x16_bf16 v[128:143], v[80:83], v[16:19], 0
    v_mfma_f32_32x32x16_bf16 v[144:159], v[80:83], v[20:23], 0
    v_mfma_f32_32x32x16_bf16 v[160:175], v[84:87], v[16:19], 0
    v_mfma_f32_32x32x16_bf16 v[176:191], v[84:87], v[20:23], 0
    buffer_load_dwordx4 v[40:43], v10, s[44:47], s7 offen offset:0 sc1
    buffer_load_dwordx4 v[44:47], v11, s[44:47], s7 offen offset:0 sc1
    buffer_load_dwordx4 v[48:51], v10, s[44:47], s8 offen offset:0 sc1
    buffer_load_dwordx4 v[52:55], v11, s[44:47], s8 offen offset:0 sc1
    s_waitcnt vmcnt(7)
    v_mfma_f32_32x32x16_bf16 v[128:143], v[88:91], v[24:27], v[128:143]
    v_mfma_f32_32x32x16_bf16 v[144:159], v[88:91], v[28:31], v[144:159]
    v_mfma_f32_32x32x16_bf16 v[160:175], v[92:95], v[24:27], v[160:175]
    v_mfma_f32_32x32x16_bf16 v[176:191], v[92:95], v[28:31], v[176:191]
    buffer_load_dwordx4 v[56:59], v10, s[44:47], s9 offen offset:0 sc1
    buffer_load_dwordx4 v[60:63], v11, s[44:47], s9 offen offset:0 sc1
    buffer_load_dwordx4 v[64:67], v10, s[44:47], s10 offen offset:0 sc1
    buffer_load_dwordx4 v[68:71], v11, s[44:47], s10 offen offset:0 sc1
    s_waitcnt vmcnt(9)
    v_mfma_f32_32x32x16_bf16 v[128:143], v[96:99], v[32:35], v[128:143]
    v_mfma_f32_32x32x16_bf16 v[144:159], v[96:99], v[36:39], v[144:159]
    v_mfma_f32_32x32x16_bf16 v[160:175], v[100:103], v[32:35], v[160:175]
    v_mfma_f32_32x32x16_bf16 v[176:191], v[100:103], v[36:39], v[176:191]
    buffer_load_dwordx4 v[72:75], v10, s[44:47], s11 offen offset:0 sc1
    buffer_load_dwordx4 v[76:79], v11, s[44:47], s11 offen offset:0 sc1
    buffer_load_dwordx4 v[16:19], v10, s[44:47], s12 offen offset:0 sc1
    buffer_load_dwordx4 v[20:23], v11, s[44:47], s12 offen offset:0 sc1
    s_waitcnt vmcnt(10)
    v_mfma_f32_32x32x16_bf16 v[128:143], v[104:107], v[40:43], v[128:143]
    v_mfma_f32_32x32x16_bf16 v[144:159], v[104:107], v[44:47], v[144:159]
    v_mfma_f32_32x32x16_bf16 v[160:175], v[108:111], v[40:43], v[160:175]
    v_mfma_f32_32x32x16_bf16 v[176:191], v[108:111], v[44:47], v[176:191]
    buffer_load_dwordx4 v[24:27], v10, s[44:47], s13 offen offset:0 sc1
    buffer_load_dwordx4 v[28:31], v11, s[44:47], s13 offen offset:0 sc1
    buffer_load_dwordx4 v[32:35], v10, s[44:47], s14 offen offset:0 sc1
    buffer_load_dwordx4 v[36:39], v11, s[44:47], s14 offen offset:0 sc1
    s_waitcnt vmcnt(12)
    v_mfma_f32_32x32x16_bf16 v[128:143], v[112:115], v[48:51], v[128:143]
    v_mfma_f32_32x32x16_bf16 v[144:159], v[112:115], v[52:55], v[144:159]
    v_mfma_f32_32x32x16_bf16 v[160:175], v[116:119], v[48:51], v[160:175]
    v_mfma_f32_32x32x16_bf16 v[176:191], v[116:119], v[52:55], v[176:191]
    buffer_load_dwordx4 v[40:43], v10, s[44:47], s15 offen offset:0 sc1
    buffer_load_dwordx4 v[44:47], v11, s[44:47], s15 offen offset:0 sc1
    buffer_load_dwordx4 v[48:51], v10, s[44:47], s20 offen offset:0 sc1
    buffer_load_dwordx4 v[52:55], v11, s[44:47], s20 offen offset:0 sc1
    s_waitcnt vmcnt(14)
    v_mfma_f32_32x32x16_bf16 v[128:143], v[120:123], v[56:59], v[128:143]
    v_mfma_f32_32x32x16_bf16 v[144:159], v[120:123], v[60:63], v[144:159]
    v_mfma_f32_32x32x16_bf16 v[160:175], v[124:127], v[56:59], v[160:175]
    v_mfma_f32_32x32x16_bf16 v[176:191], v[124:127], v[60:63], v[176:191]
    buffer_load_dwordx4 v[56:59], v10, s[44:47], s21 offen offset:0 sc1
    buffer_load_dwordx4 v[60:63], v11, s[44:47], s21 offen offset:0 sc1
    s_waitcnt vmcnt(14)
    v_mfma_f32_32x32x16_bf16 v[128:143], v[192:195], v[64:67], v[128:143]
    v_mfma_f32_32x32x16_bf16 v[144:159], v[192:195], v[68:71], v[144:159]
    v_mfma_f32_32x32x16_bf16 v[160:175], v[196:199], v[64:67], v[160:175]
    v_mfma_f32_32x32x16_bf16 v[176:191], v[196:199], v[68:71], v[176:191]
    s_movk_i32 s101, 32767
LP_62:
    v_cmp_eq_u32 vcc, s77, v1
    s_nop 1
    s_and_b32 vcc_lo, vcc_lo, 16383
    s_cmp_eq_u32 vcc_lo, 16383
    s_cbranch_scc1 OK_61
    s_sub_u32 s101, s101, 1
    s_cbranch_scc1 OK_61
    s_sleep 1
    buffer_load_dword v1, v7, s[48:51], s74 offen sc1
    s_waitcnt vmcnt(0)
    s_branch LP_62
OK_61:
    v_lshlrev_b32 v7, 2, v14
    buffer_load_dwordx4 v[64:67], v10, s[44:47], s4 offen offset:2048 sc1
    buffer_load_dwordx4 v[68:71], v11, s[44:47], s4 offen offset:2048 sc1
    s_waitcnt vmcnt(14)
    v_mfma_f32_32x32x16_bf16 v[128:143], v[200:203], v[72:75], v[128:143]
    v_lshlrev_b32 v96, 16, v248
    v_and_b32 v97, 0xffff0000, v248
    v_lshlrev_b32 v98, 16, v249
    v_and_b32 v99, 0xffff0000, v249
    v_mfma_f32_32x32x16_bf16 v[144:159], v[200:203], v[76:79], v[144:159]
    v_lshlrev_b32 v100, 16, v250
    v_and_b32 v101, 0xffff0000, v250
    v_lshlrev_b32 v102, 16, v251
    v_and_b32 v103, 0xffff0000, v251
    v_mfma_f32_32x32x16_bf16 v[160:175], v[204:207], v[72:75], v[160:175]
    v_lshlrev_b32 v104, 16, v252
    v_and_b32 v105, 0xffff0000, v252
    v_lshlrev_b32 v106, 16, v253
    v_and_b32 v107, 0xffff0000, v253
    v_mfma_f32_32x32x16_bf16 v[176:191], v[204:207], v[76:79], v[176:191]
    v_lshlrev_b32 v108, 16, v254
    v_and_b32 v109, 0xffff0000, v254
    v_lshlrev_b32 v110, 16, v255
    v_and_b32 v111, 0xffff0000, v255
    buffer_load_dwordx4 v[72:75], v10, s[44:47], s5 offen offset:2048 sc1
    buffer_load_dwordx4 v[76:79], v11, s[44:47], s5 offen offset:2048 sc1
    s_waitcnt vmcnt(14)
    v_mfma_f32_32x32x16_bf16 v[128:143], v[208:211], v[16:19], v[128:143]
    v_sub_f32 v112, v96, v3
    v_sub_f32 v113, v97, v3
    v_sub_f32 v114, v98, v3
    v_sub_f32 v115, v99, v3
    v_mfma_f32_32x32x16_bf16 v[144:159], v[208:211], v[20:23], v[144:159]
    v_sub_f32 v116, v100, v3
    v_sub_f32 v117, v101, v3
    v_sub_f32 v118, v102, v3
    v_sub_f32 v119, v103, v3
    v_mfma_f32_32x32x16_bf16 v[160:175], v[212:215], v[16:19], v[160:175]
    v_sub_f32 v120, v104, v3
    v_sub_f32 v121, v105, v3
    v_sub_f32 v122, v106, v3
    v_sub_f32 v123, v107, v3
    v_mfma_f32_32x32x16_bf16 v[176:191], v[212:215], v[20:23], v[176:191]
    v_sub_f32 v124, v108, v3
    v_sub_f32 v125, v109, v3
    v_sub_f32 v126, v110, v3
    v_sub_f32 v127, v111, v3
    buffer_load_dwordx4 v[16:19], v10, s[44:47], s6 offen offset:2048 sc1
    buffer_load_dwordx4 v[20:23], v11, s[44:47], s6 offen offset:2048 sc1
    s_waitcnt vmcnt(14)
    v_mfma_f32_32x32x16_bf16 v[128:143], v[216:219], v[24:27], v[128:143]
    v_mul_f32 v112, v112, v4
    v_mul_f32 v113, v113, v4
    v_mul_f32 v114, v114, v4
    v_mul_f32 v115, v115, v4
    v_mfma_f32_32x32x16_bf16 v[144:159], v[216:219], v[28:31], v[144:159]
    v_mul_f32 v116, v116, v4
    v_mul_f32 v117, v117, v4
    v_mul_f32 v118, v118, v4
    v_mul_f32 v119, v119, v4
    v_mfma_f32_32x32x16_bf16 v[160:175], v[220:223], v[24:27], v[160:175]
    v_mul_f32 v120, v120, v4
    v_mul_f32 v121, v121, v4
    v_mul_f32 v122, v122, v4
    v_mul_f32 v123, v123, v4
    v_mfma_f32_32x32x16_bf16 v[176:191], v[220:223], v[28:31], v[176:191]
    v_mul_f32 v124, v124, v4
    v_mul_f32 v125, v125, v4
    v_mul_f32 v126, v126, v4
    v_mul_f32 v127, v127, v4
    buffer_load_dwordx4 v[24:27], v10, s[44:47], s7 offen offset:2048 sc1
    buffer_load_dwordx4 v[28:31], v11, s[44:47], s7 offen offset:2048 sc1
    ds_read_b64_tr_b16 v[240:241], v13 offset:0
    ds_read_b64_tr_b16 v[242:243], v13 offset:512
    ds_read_b64_tr_b16 v[244:245], v13 offset:1024
    ds_read_b64_tr_b16 v[246:247], v13 offset:1536
    s_waitcnt vmcnt(14)
    v_mfma_f32_32x32x16_bf16 v[128:143], v[224:227], v[32:35], v[128:143]
    v_mfma_f32_32x32x16_bf16 v[144:159], v[224:227], v[36:39], v[144:159]
    v_mfma_f32_32x32x16_bf16 v[160:175], v[228:231], v[32:35], v[160:175]
    v_mfma_f32_32x32x16_bf16 v[176:191], v[228:231], v[36:39], v[176:191]
    buffer_load_dwordx4 v[32:35], v10, s[44:47], s8 offen offset:2048 sc1
    buffer_load_dwordx4 v[36:39], v11, s[44:47], s8 offen offset:2048 sc1
    ds_read_b64_tr_b16 v[232:233], v13 offset:2048
    ds_read_b64_tr_b16 v[234:235], v13 offset:2560
    ds_read_b64_tr_b16 v[236:237], v13 offset:3072
    ds_read_b64_tr_b16 v[238:239], v13 offset:3584
    s_waitcnt vmcnt(14) lgkmcnt(4)
    v_mfma_f32_32x32x16_bf16 v[128:143], v[240:243], v[40:43], v[128:143]
    v_mfma_f32_32x32x16_bf16 v[144:159], v[240:243], v[44:47], v[144:159]
    v_mfma_f32_32x32x16_bf16 v[160:175], v[244:247], v[40:43], v[160:175]
    v_mfma_f32_32x32x16_bf16 v[176:191], v[244:247], v[44:47], v[176:191]
    buffer_load_dwordx4 v[40:43], v10, s[44:47], s9 offen offset:2048 sc1
    buffer_load_dwordx4 v[44:47], v11, s[44:47], s9 offen offset:2048 sc1
    s_add_u32 s94, s69, 8
    s_sub_u32 s72, s94, 14
    s_cselect_b32 s94, s94, s72
    s_mul_i32 s94, s94, 114688
    s_add_u32 s94, s94, 28672
    s_add_u32 m0, s95, 0
    s_add_u32 s70, s94, s99
    buffer_load_dwordx4 v8, s[40:43], s70 offen lds
    s_add_u32 m0, s95, 1024
    s_add_u32 s70, s94, s100
    buffer_load_dwordx4 v8, s[40:43], s70 offen lds
    ds_read_b64_tr_b16 v[240:241], v13 offset:4096
    ds_read_b64_tr_b16 v[242:243], v13 offset:4608
    ds_read_b64_tr_b16 v[244:245], v13 offset:5120
    ds_read_b64_tr_b16 v[246:247], v13 offset:5632
    s_waitcnt vmcnt(16) lgkmcnt(4)
    v_mfma_f32_32x32x16_bf16 v[128:143], v[232:235], v[48:51], v[128:143]
    v_mfma_f32_32x32x16_bf16 v[144:159], v[232:235], v[52:55], v[144:159]
    v_mfma_f32_32x32x16_bf16 v[160:175], v[236:239], v[48:51], v[160:175]
    v_mfma_f32_32x32x16_bf16 v[176:191], v[236:239], v[52:55], v[176:191]
    buffer_load_dwordx4 v[48:51], v10, s[44:47], s10 offen offset:2048 sc1
    buffer_load_dwordx4 v[52:55], v11, s[44:47], s10 offen offset:2048 sc1
    s_add_u32 s94, s69, 9
    s_sub_u32 s72, s94, 14
    s_cselect_b32 s94, s94, s72
    s_mul_i32 s94, s94, 114688
    s_add_u32 s94, s94, 28672
    s_add_u32 m0, s95, 2048
    s_add_u32 s70, s94, s99
    buffer_load_dwordx4 v8, s[40:43], s70 offen lds
    s_add_u32 m0, s95, 3072
    s_add_u32 s70, s94, s100
    buffer_load_dwordx4 v8, s[40:43], s70 offen lds
    ds_read_b64_tr_b16 v[232:233], v13 offset:6144
    ds_read_b64_tr_b16 v[234:235], v13 offset:6656
    ds_read_b64_tr_b16 v[236:237], v13 offset:7168
    ds_read_b64_tr_b16 v[238:239], v13 offset:7680
    s_waitcnt vmcnt(18) lgkmcnt(4)
    v_mfma_f32_32x32x16_bf16 v[128:143], v[240:243], v[56:59], v[128:143]
    v_mfma_f32_32x32x16_bf16 v[144:159], v[240:243], v[60:63], v[144:159]
    v_mfma_f32_32x32x16_bf16 v[160:175], v[244:247], v[56:59], v[160:175]
    v_mfma_f32_32x32x16_bf16 v[176:191], v[244:247], v[60:63], v[176:191]
    buffer_load_dwordx4 v[56:59], v10, s[44:47], s11 offen offset:2048 sc1
    buffer_load_dwordx4 v[60:63], v11, s[44:47], s11 offen offset:2048 sc1
    s_add_u32 s94, s69, 10
    s_sub_u32 s72, s94, 14
    s_cselect_b32 s94, s94, s72
    s_mul_i32 s94, s94, 114688
    s_add_u32 s94, s94, 28672
    s_add_u32 m0, s95, 4096
    s_add_u32 s70, s94, s99
    buffer_load_dwordx4 v8, s[40:43], s70 offen lds
    s_add_u32 m0, s95, 5120
    s_add_u32 s70, s94, s100
    buffer_load_dwordx4 v8, s[40:43], s70 offen lds
    ds_read_b64_tr_b16 v[240:241], v13 offset:32768
    ds_read_b64_tr_b16 v[242:243], v13 offset:33280
    ds_read_b64_tr_b16 v[244:245], v13 offset:33792
    ds_read_b64_tr_b16 v[246:247], v13 offset:34304
    s_waitcnt vmcnt(20) lgkmcnt(4)
    v_mfma_f32_32x32x16_bf16 v[128:143], v[232:235], v[64:67], v[128:143]
    v_mfma_f32_32x32x16_bf16 v[144:159], v[232:235], v[68:71], v[144:159]
    v_mfma_f32_32x32x16_bf16 v[160:175], v[236:239], v[64:67], v[160:175]
    v_mfma_f32_32x32x16_bf16 v[176:191], v[236:239], v[68:71], v[176:191]
    buffer_load_dwordx4 v[64:67], v10, s[44:47], s12 offen offset:2048 sc1
    buffer_load_dwordx4 v[68:71], v11, s[44:47], s12 offen offset:2048 sc1
    s_add_u32 s94, s69, 11
    s_sub_u32 s72, s94, 14
    s_cselect_b32 s94, s94, s72
    s_mul_i32 s94, s94, 114688
    s_add_u32 s94, s94, 28672
    s_add_u32 m0, s95, 6144
    s_add_u32 s70, s94, s99
    buffer_load_dwordx4 v8, s[40:43], s70 offen lds
    s_add_u32 m0, s95, 7168
    s_add_u32 s70, s94, s100
    buffer_load_dwordx4 v8, s[40:43], s70 offen lds
    buffer_load_dword v1, v7, s[48:51], s73 offen sc1
    ds_read_b64_tr_b16 v[232:233], v13 offset:34816
    ds_read_b64_tr_b16 v[234:235], v13 offset:35328
    ds_read_b64_tr_b16 v[236:237], v13 offset:35840
    ds_read_b64_tr_b16 v[238:239], v13 offset:36352
    s_waitcnt vmcnt(23) lgkmcnt(4)
    v_mfma_f32_32x32x16_bf16 v[128:143], v[240:243], v[72:75], v[128:143]
    v_mfma_f32_32x32x16_bf16 v[144:159], v[240:243], v[76:79], v[144:159]
    v_mfma_f32_32x32x16_bf16 v[160:175], v[244:247], v[72:75], v[160:175]
    v_mfma_f32_32x32x16_bf16 v[176:191], v[244:247], v[76:79], v[176:191]
    buffer_load_dwordx4 v[72:75], v10, s[44:47], s13 offen offset:2048 sc1
    buffer_load_dwordx4 v[76:79], v11, s[44:47], s13 offen offset:2048 sc1
    s_add_u32 s94, s69, 12
    s_sub_u32 s72, s94, 14
    s_cselect_b32 s94, s94, s72
    s_mul_i32 s94, s94, 114688
    s_add_u32 s94, s94, 28672
    s_add_u32 m0, s95, 32768
    s_add_u32 s70, s94, s99
    buffer_load_dwordx4 v8, s[40:43], s70 offen lds
    s_add_u32 m0, s95, 33792
    s_add_u32 s70, s94, s100
    buffer_load_dwordx4 v8, s[40:43], s70 offen lds
    ds_read_b64_tr_b16 v[240:241], v13 offset:36864
    ds_read_b64_tr_b16 v[242:243], v13 offset:37376
    ds_read_b64_tr_b16 v[244:245], v13 offset:37888
    ds_read_b64_tr_b16 v[246:247], v13 offset:38400
    s_waitcnt vmcnt(25) lgkmcnt(4)
    v_mfma_f32_32x32x16_bf16 v[128:143], v[232:235], v[16:19], v[128:143]
    v_mfma_f32_32x32x16_bf16 v[144:159], v[232:235], v[20:23], v[144:159]
    v_mfma_f32_32x32x16_bf16 v[160:175], v[236:239], v[16:19], v[160:175]
    v_mfma_f32_32x32x16_bf16 v[176:191], v[236:239], v[20:23], v[176:191]
    buffer_load_dwordx4 v[16:19], v10, s[44:47], s14 offen offset:2048 sc1
    buffer_load_dwordx4 v[20:23], v11, s[44:47], s14 offen offset:2048 sc1
    s_add_u32 s94, s69, 13
    s_sub_u32 s72, s94, 14
    s_cselect_b32 s94, s94, s72
    s_mul_i32 s94, s94, 114688
    s_add_u32 s94, s94, 28672
    s_add_u32 m0, s95, 34816
    s_add_u32 s70, s94, s99
    buffer_load_dwordx4 v8, s[40:43], s70 offen lds
    s_add_u32 m0, s95, 35840
    s_add_u32 s70, s94, s100
    buffer_load_dwordx4 v8, s[40:43], s70 offen lds
    ds_read_b64_tr_b16 v[232:233], v13 offset:38912
    ds_read_b64_tr_b16 v[234:235], v13 offset:39424
    ds_read_b64_tr_b16 v[236:237], v13 offset:39936
    ds_read_b64_tr_b16 v[238:239], v13 offset:40448
    s_waitcnt vmcnt(27) lgkmcnt(4)
    v_mfma_f32_32x32x16_bf16 v[128:143], v[240:243], v[24:27], v[128:143]
    v_mfma_f32_32x32x16_bf16 v[144:159], v[240:243], v[28:31], v[144:159]
    v_mfma_f32_32x32x16_bf16 v[160:175], v[244:247], v[24:27], v[160:175]
    v_mfma_f32_32x32x16_bf16 v[176:191], v[244:247], v[28:31], v[176:191]
    buffer_load_dwordx4 v[24:27], v10, s[44:47], s15 offen offset:2048 sc1
    buffer_load_dwordx4 v[28:31], v11, s[44:47], s15 offen offset:2048 sc1
    ds_read_b64_tr_b16 v[240:241], v5 offset:0
    ds_read_b64_tr_b16 v[242:243], v5 offset:512
    ds_read_b64_tr_b16 v[244:245], v5 offset:1024
    ds_read_b64_tr_b16 v[246:247], v5 offset:1536
    s_waitcnt vmcnt(27) lgkmcnt(4)
    v_mfma_f32_32x32x16_bf16 v[128:143], v[232:235], v[32:35], v[128:143]
    v_mfma_f32_32x32x16_bf16 v[144:159], v[232:235], v[36:39], v[144:159]
    v_mfma_f32_32x32x16_bf16 v[160:175], v[236:239], v[32:35], v[160:175]
    v_mfma_f32_32x32x16_bf16 v[176:191], v[236:239], v[36:39], v[176:191]
    buffer_load_dwordx4 v[32:35], v10, s[44:47], s20 offen offset:2048 sc1
    buffer_load_dwordx4 v[36:39], v11, s[44:47], s20 offen offset:2048 sc1
    ds_read_b64_tr_b16 v[232:233], v5 offset:2048
    ds_read_b64_tr_b16 v[234:235], v5 offset:2560
    ds_read_b64_tr_b16 v[236:237], v5 offset:3072
    ds_read_b64_tr_b16 v[238:239], v5 offset:3584
    s_waitcnt vmcnt(27) lgkmcnt(4)
    v_mfma_f32_32x32x16_bf16 v[128:143], v[240:243], v[40:43], v[128:143]
    v_mfma_f32_32x32x16_bf16 v[144:159], v[240:243], v[44:47], v[144:159]
    v_mfma_f32_32x32x16_bf16 v[160:175], v[244:247], v[40:43], v[160:175]
    v_mfma_f32_32x32x16_bf16 v[176:191], v[244:247], v[44:47], v[176:191]
    buffer_load_dwordx4 v[40:43], v10, s[44:47], s21 offen offset:2048 sc1
    buffer_load_dwordx4 v[44:47], v11, s[44:47], s21 offen offset:2048 sc1
    ds_read_b64_tr_b16 v[240:241], v5 offset:4096
    ds_read_b64_tr_b16 v[242:243], v5 offset:4608
    ds_read_b64_tr_b16 v[244:245], v5 offset:5120
    ds_read_b64_tr_b16 v[246:247], v5 offset:5632
    s_waitcnt vmcnt(25) lgkmcnt(4)
    v_mfma_f32_32x32x16_bf16 v[128:143], v[232:235], v[48:51], v[128:143]
    v_mfma_f32_32x32x16_bf16 v[144:159], v[232:235], v[52:55], v[144:159]
    v_mfma_f32_32x32x16_bf16 v[160:175], v[236:239], v[48:51], v[160:175]
    v_mfma_f32_32x32x16_bf16 v[176:191], v[236:239], v[52:55], v[176:191]
    ds_read_b64_tr_b16 v[232:233], v13 offset:0
    ds_read_b64_tr_b16 v[234:235], v13 offset:512
    ds_read_b64_tr_b16 v[236:237], v13 offset:1024
    ds_read_b64_tr_b16 v[238:239], v13 offset:1536
    s_waitcnt vmcnt(21) lgkmcnt(4)
    v_mfma_f32_32x32x16_bf16 v[128:143], v[240:243], v[56:59], v[128:143]
    v_mfma_f32_32x32x16_bf16 v[144:159], v[240:243], v[60:63], v[144:159]
    v_mfma_f32_32x32x16_bf16 v[160:175], v[244:247], v[56:59], v[160:175]
    v_mfma_f32_32x32x16_bf16 v[176:191], v[244:247], v[60:63], v[176:191]
    ds_read_b64_tr_b16 v[240:241], v13 offset:2048
    ds_read_b64_tr_b16 v[242:243], v13 offset:2560
    ds_read_b64_tr_b16 v[244:245], v13 offset:3072
    ds_read_b64_tr_b16 v[246:247], v13 offset:3584
    s_waitcnt vmcnt(17) lgkmcnt(4)
    v_mfma_f32_32x32x16_bf16 v[128:143], v[232:235], v[64:67], v[128:143]
    v_mfma_f32_32x32x16_bf16 v[144:159], v[232:235], v[68:71], v[144:159]
    v_mfma_f32_32x32x16_bf16 v[160:175], v[236:239], v[64:67], v[160:175]
    v_mfma_f32_32x32x16_bf16 v[176:191], v[236:239], v[68:71], v[176:191]
    s_waitcnt vmcnt(14)
    s_movk_i32 s101, 32767
LP_64:
    v_cmp_eq_u32 vcc, s77, v1
    s_nop 1
    s_and_b32 vcc_lo, vcc_lo, 4294967295
    s_cmp_eq_u32 vcc_lo, 4294967295
    s_cbranch_scc1 OK_63
    s_sub_u32 s101, s101, 1
    s_cbranch_scc1 OK_63
    s_sleep 1
    buffer_load_dword v1, v7, s[48:51], s73 offen sc1
    s_waitcnt vmcnt(0)
    s_branch LP_64
OK_63:
    buffer_load_dwordx4 v[80:83], v6, s[60:63], s75 offen sc1
    s_add_u32 s75, s75, 16*4096
    buffer_load_dwordx4 v[84:87], v6, s[60:63], s75 offen sc1
    ds_read_b64_tr_b16 v[232:233], v13 offset:4096
    ds_read_b64_tr_b16 v[234:235], v13 offset:4608
    ds_read_b64_tr_b16 v[236:237], v13 offset:5120
    ds_read_b64_tr_b16 v[238:239], v13 offset:5632
    s_waitcnt vmcnt(14) lgkmcnt(4)
    v_mfma_f32_32x32x16_bf16 v[128:143], v[240:243], v[72:75], v[128:143]
    v_mfma_f32_32x32x16_bf16 v[144:159], v[240:243], v[76:79], v[144:159]
    v_mfma_f32_32x32x16_bf16 v[160:175], v[244:247], v[72:75], v[160:175]
    v_mfma_f32_32x32x16_bf16 v[176:191], v[244:247], v[76:79], v[176:191]
    ds_read_b64_tr_b16 v[240:241], v13 offset:6144
    ds_read_b64_tr_b16 v[242:243], v13 offset:6656
    ds_read_b64_tr_b16 v[244:245], v13 offset:7168
    ds_read_b64_tr_b16 v[246:247], v13 offset:7680
    s_waitcnt vmcnt(10) lgkmcnt(4)
    v_mfma_f32_32x32x16_bf16 v[128:143], v[232:235], v[16:19], v[128:143]
    v_mfma_f32_32x32x16_bf16 v[144:159], v[232:235], v[20:23], v[144:159]
    v_mfma_f32_32x32x16_bf16 v[160:175], v[236:239], v[16:19], v[160:175]
    v_mfma_f32_32x32x16_bf16 v[176:191], v[236:239], v[20:23], v[176:191]
    ds_read_b64_tr_b16 v[232:233], v13 offset:32768
    ds_read_b64_tr_b16 v[234:235], v13 offset:33280
    ds_read_b64_tr_b16 v[236:237], v13 offset:33792
    ds_read_b64_tr_b16 v[238:239], v13 offset:34304
    s_waitcnt vmcnt(6) lgkmcnt(4)
    v_mfma_f32_32x32x16_bf16 v[128:143], v[240:243], v[24:27], v[128:143]
    v_mfma_f32_32x32x16_bf16 v[144:159], v[240:243], v[28:31], v[144:159]
    v_mfma_f32_32x32x16_bf16 v[160:175], v[244:247], v[24:27], v[160:175]
    v_mfma_f32_32x32x16_bf16 v[176:191], v[244:247], v[28:31], v[176:191]
    ds_read_b64_tr_b16 v[240:241], v13 offset:34816
    ds_read_b64_tr_b16 v[242:243], v13 offset:35328
    ds_read_b64_tr_b16 v[244:245], v13 offset:35840
    ds_read_b64_tr_b16 v[246:247], v13 offset:36352
    s_waitcnt vmcnt(4) lgkmcnt(4)
    v_mfma_f32_32x32x16_bf16 v[128:143], v[232:235], v[32:35], v[128:143]
    v_mfma_f32_32x32x16_bf16 v[144:159], v[232:235], v[36:39], v[144:159]
    v_mfma_f32_32x32x16_bf16 v[160:175], v[236:239], v[32:35], v[160:175]
    v_mfma_f32_32x32x16_bf16 v[176:191], v[236:239], v[36:39], v[176:191]
    s_waitcnt vmcnt(2) lgkmcnt(0)
    v_mfma_f32_32x32x16_bf16 v[144:159], v[240:243], v[44:47], v[144:159]
    v_mfma_f32_32x32x16_bf16 v[160:175], v[244:247], v[40:43], v[160:175]
    v_mfma_f32_32x32x16_bf16 v[176:191], v[244:247], v[44:47], v[176:191]
    v_mfma_f32_32x32x16_bf16 v[128:143], v[240:243], v[40:43], v[128:143]
    s_waitcnt vmcnt(0)
    v_add_u32 v7, 0x10000, v2
    ds_write_b128 v7, v[80:83] offset:6144
    ds_write_b128 v7, v[84:87] offset:7168
    ds_read_b64_tr_b16 v[88:89], v5 offset:6144
    ds_read_b64_tr_b16 v[90:91], v5 offset:6656
    ds_read_b64_tr_b16 v[92:93], v5 offset:7168
    ds_read_b64_tr_b16 v[94:95], v5 offset:7680
    s_nop 0
    ds_write_b128 v2, v[144:147] offset:0
    s_waitcnt lgkmcnt(1)
    v_lshlrev_b32 v80, 16, v88
    v_and_b32 v81, 0xffff0000, v88
    v_fmac_f32 v96, v112, v80
    ds_write_b128 v2, v[148:151] offset:1024
    v_fmac_f32 v97, v113, v81
    v_lshlrev_b32 v82, 16, v89
    v_and_b32 v83, 0xffff0000, v89
    ds_write_b128 v2, v[152:155] offset:2048
    v_fmac_f32 v98, v114, v82
    v_fmac_f32 v99, v115, v83
    v_lshlrev_b32 v84, 16, v90
    ds_write_b128 v2, v[156:159] offset:3072
    v_and_b32 v85, 0xffff0000, v90
    v_fmac_f32 v100, v116, v84
    v_fmac_f32 v101, v117, v85
    ds_write_b128 v2, v[160:163] offset:4096
    v_lshlrev_b32 v86, 16, v91
    v_and_b32 v87, 0xffff0000, v91
    v_fmac_f32 v102, v118, v86
    ds_write_b128 v2, v[164:167] offset:5120
    v_fmac_f32 v103, v119, v87
    v_lshlrev_b32 v80, 16, v92
    v_and_b32 v81, 0xffff0000, v92
    ds_write_b128 v2, v[168:171] offset:6144
    v_fmac_f32 v104, v120, v80
    v_fmac_f32 v105, v121, v81
    v_lshlrev_b32 v82, 16, v93
    ds_write_b128 v2, v[172:175] offset:7168
    v_and_b32 v83, 0xffff0000, v93
    v_fmac_f32 v106, v122, v82
    v_fmac_f32 v107, v123, v83
    ds_write_b128 v2, v[176:179] offset:32768
    v_lshlrev_b32 v84, 16, v94
    v_and_b32 v85, 0xffff0000, v94
    v_fmac_f32 v108, v124, v84
    ds_write_b128 v2, v[180:183] offset:33792
    v_fmac_f32 v109, v125, v85
    v_lshlrev_b32 v86, 16, v95
    v_and_b32 v87, 0xffff0000, v95
    ds_write_b128 v2, v[184:187] offset:34816
    v_fmac_f32 v110, v126, v86
    v_fmac_f32 v111, v127, v87
    v_cvt_pk_bf16_f32 v88, v96, v97
    ds_write_b128 v2, v[188:191] offset:35840
    v_cvt_pk_bf16_f32 v89, v98, v99
    v_cvt_pk_bf16_f32 v90, v100, v101
    v_cvt_pk_bf16_f32 v91, v102, v103
    v_cvt_pk_bf16_f32 v92, v104, v105
    v_cvt_pk_bf16_f32 v93, v106, v107
    v_cvt_pk_bf16_f32 v94, v108, v109
    v_cvt_pk_bf16_f32 v95, v110, v111
    v_lshlrev_b32 v96, 16, v88
    v_and_b32 v97, 0xffff0000, v88
    v_lshlrev_b32 v98, 16, v89
    v_and_b32 v99, 0xffff0000, v89
    v_lshlrev_b32 v100, 16, v90
    v_and_b32 v101, 0xffff0000, v90
    v_lshlrev_b32 v102, 16, v91
    v_and_b32 v103, 0xffff0000, v91
    v_lshlrev_b32 v104, 16, v92
    v_and_b32 v105, 0xffff0000, v92
    v_lshlrev_b32 v106, 16, v93
    v_and_b32 v107, 0xffff0000, v93
    v_lshlrev_b32 v108, 16, v94
    v_and_b32 v109, 0xffff0000, v94
    v_lshlrev_b32 v110, 16, v95
    v_and_b32 v111, 0xffff0000, v95
    s_xor_b32 s70, s92, 1
    s_lshl_b32 s70, s70, 13
    v_add_u32 v11, s70, v9
    s_xor_b32 s70, s92, 2
    s_lshl_b32 s70, s70, 13
    v_add_u32 v12, s70, v9
    s_xor_b32 s70, s92, 3
    s_lshl_b32 s70, s70, 13
    v_add_u32 v13, s70, v9
    v_mul_u32_u24 v1, 896, v14
    v_lshl_add_u32 v1, v15, 4, v1
    v_add_f32 v128, v128, v96
    v_add_f32 v129, v129, v97
    v_add_f32 v130, v130, v98
    v_add_f32 v131, v131, v99
    v_add_f32 v132, v132, v100
    v_add_f32 v133, v133, v101
    v_add_f32 v134, v134, v102
    v_add_f32 v135, v135, v103
    v_add_f32 v136, v136, v104
    v_add_f32 v137, v137, v105
    v_add_f32 v138, v138, v106
    v_add_f32 v139, v139, v107
    v_add_f32 v140, v140, v108
    v_add_f32 v141, v141, v109
    v_add_f32 v142, v142, v110
    v_add_f32 v143, v143, v111
    s_waitcnt lgkmcnt(0)
    s_barrier
    ds_read_b128 v[16:19], v11 offset:0
    ds_read_b128 v[32:35], v12 offset:4096
    ds_read_b128 v[48:51], v13 offset:32768
    ds_read_b128 v[20:23], v11 offset:1024
    ds_read_b128 v[36:39], v12 offset:5120
    ds_read_b128 v[52:55], v13 offset:33792
    ds_read_b128 v[24:27], v11 offset:2048
    ds_read_b128 v[40:43], v12 offset:6144
    ds_read_b128 v[56:59], v13 offset:34816
    ds_read_b128 v[28:31], v11 offset:3072
    ds_read_b128 v[44:47], v12 offset:7168
    ds_read_b128 v[60:63], v13 offset:35840
    s_waitcnt lgkmcnt(9)
    v_add_f32 v128, v128, v16
    v_add_f32 v32, v32, v48
    v_add_f32 v129, v129, v17
    v_add_f32 v33, v33, v49
    v_add_f32 v130, v130, v18
    v_add_f32 v34, v34, v50
    v_add_f32 v131, v131, v19
    v_add_f32 v35, v35, v51
    v_add_f32 v128, v128, v32
    v_add_f32 v129, v129, v33
    v_add_f32 v130, v130, v34
    v_add_f32 v131, v131, v35
    v_cvt_pk_bf16_f32 v64, v128, v129
    v_cvt_pk_bf16_f32 v65, v130, v131
    s_waitcnt lgkmcnt(6)
    v_add_f32 v132, v132, v20
    v_add_f32 v36, v36, v52
    v_add_f32 v133, v133, v21
    v_add_f32 v37, v37, v53
    v_add_f32 v134, v134, v22
    v_add_f32 v38, v38, v54
    v_add_f32 v135, v135, v23
    v_add_f32 v39, v39, v55
    v_add_f32 v132, v132, v36
    v_add_f32 v133, v133, v37
    v_add_f32 v134, v134, v38
    v_add_f32 v135, v135, v39
    v_cvt_pk_bf16_f32 v66, v132, v133
    v_cvt_pk_bf16_f32 v67, v134, v135
    s_nop 0
    v_permlane32_swap_b32 v64, v66
    v_permlane32_swap_b32 v65, v67
    buffer_store_dwordx4 v[64:67], v1, s[56:59], s96 offen offset:0
    s_waitcnt lgkmcnt(3)
    v_add_f32 v136, v136, v24
    v_add_f32 v40, v40, v56
    v_add_f32 v137, v137, v25
    v_add_f32 v41, v41, v57
    v_add_f32 v138, v138, v26
    v_add_f32 v42, v42, v58
    v_add_f32 v139, v139, v27
    v_add_f32 v43, v43, v59
    v_add_f32 v136, v136, v40
    v_add_f32 v137, v137, v41
    v_add_f32 v138, v138, v42
    v_add_f32 v139, v139, v43
    v_cvt_pk_bf16_f32 v68, v136, v137
    v_cvt_pk_bf16_f32 v69, v138, v139
    s_waitcnt lgkmcnt(0)
    v_add_f32 v140, v140, v28
    v_add_f32 v44, v44, v60
    v_add_f32 v141, v141, v29
    v_add_f32 v45, v45, v61
    v_add_f32 v142, v142, v30
    v_add_f32 v46, v46, v62
    v_add_f32 v143, v143, v31
    v_add_f32 v47, v47, v63
    v_add_f32 v140, v140, v44
    v_add_f32 v141, v141, v45
    v_add_f32 v142, v142, v46
    v_add_f32 v143, v143, v47
    v_cvt_pk_bf16_f32 v70, v140, v141
    v_cvt_pk_bf16_f32 v71, v142, v143
    s_nop 0
    v_permlane32_swap_b32 v68, v70
    v_permlane32_swap_b32 v69, v71
    buffer_store_dwordx4 v[68:71], v1, s[56:59], s96 offen offset:32
    s_endpgm
FAR_55:
    buffer_wbl2 sc1
    s_waitcnt vmcnt(0)
    buffer_store_dword v12, v10, s[48:51], s18 offen offset:0 sc1
    s_branch FLG_56
FAR_57:
    buffer_wbl2 sc1
    s_waitcnt vmcnt(0)
    buffer_store_dword v12, v10, s[48:51], s18 offen offset:64 sc1
    s_branch FLG_58
LBAD_34:
    s_movk_i32 s101, 32767
LLP_65:
    ds_read_b32 v120, v117 offset:96
    s_waitcnt lgkmcnt(0)
    v_cmp_le_u32 vcc, 4, v120
    s_cbranch_vccnz LOK_35
    s_sub_u32 s101, s101, 1
    s_cbranch_scc0 LLP_65
    s_branch LOK_35
LBAD_36:
    s_movk_i32 s101, 32767
LLP_66:
    ds_read_b32 v120, v117 offset:100
    s_waitcnt lgkmcnt(0)
    v_cmp_le_u32 vcc, 4, v120
    s_cbranch_vccnz LOK_37
    s_sub_u32 s101, s101, 1
    s_cbranch_scc0 LLP_66
    s_branch LOK_37
LBAD_38:
    s_movk_i32 s101, 32767
LLP_67:
    ds_read_b32 v120, v117 offset:104
    s_waitcnt lgkmcnt(0)
    v_cmp_le_u32 vcc, 4, v120
    s_cbranch_vccnz LOK_39
    s_sub_u32 s101, s101, 1
    s_cbranch_scc0 LLP_67
    s_branch LOK_39
LBAD_42:
    s_movk_i32 s101, 32767
LLP_68:
    ds_read_b32 v120, v117 offset:108
    s_waitcnt lgkmcnt(0)
    v_cmp_le_u32 vcc, 4, v120
    s_cbranch_vccnz LOK_43
    s_sub_u32 s101, s101, 1
    s_cbranch_scc0 LLP_68
    s_branch LOK_43
LBAD_44:
    s_movk_i32 s101, 32767
LLP_69:
    ds_read_b32 v120, v117 offset:112
    s_waitcnt lgkmcnt(0)
    v_cmp_le_u32 vcc, 4, v120
    s_cbranch_vccnz LOK_45
    s_sub_u32 s101, s101, 1
    s_cbranch_scc0 LLP_69
    s_branch LOK_45
LBAD_46:
    s_movk_i32 s101, 32767
LLP_70:
    ds_read_b32 v120, v117 offset:116
    s_waitcnt lgkmcnt(0)
    v_cmp_le_u32 vcc, 4, v120
    s_cbranch_vccnz LOK_47
    s_sub_u32 s101, s101, 1
    s_cbranch_scc0 LLP_70
    s_branch LOK_47
LBAD_48:
    s_movk_i32 s101, 32767
LLP_71:
    ds_read_b32 v120, v117 offset:120
    s_waitcnt lgkmcnt(0)
    v_cmp_le_u32 vcc, 4, v120
    s_cbranch_vccnz LOK_49
    s_sub_u32 s101, s101, 1
    s_cbranch_scc0 LLP_71
    s_branch LOK_49
.p2align 6
L_HELP:
    v_lshrrev_b32 v1, 3, v0
    v_and_b32 v2, 7, v0
    v_mul_u32_u24 v3, 896, v1
    v_lshl_add_u32 v3, v2, 4, v3
    v_mul_u32_u24 v4, 3584, v1
    v_lshl_add_u32 v4, v2, 4, v4
    v_cmp_eq_u32 vcc, 0, v0
    v_mov_b32 v5, 0x7fffffff
    s_nop 0
    v_cndmask_b32 v5, v5, 0, vcc
    v_mov_b32 v6, 0
    s_lshl_b32 s29, s2, 3
    s_add_u32 s29, s29, s28
    s_mul_i32 s30, s29, 8*896
    s_mul_i32 s31, s28, 56*3584
    s_lshl_b32 s56, s2, 7
    s_add_u32 s31, s31, s56
    s_cmp_lt_u32 s2, 28
    s_cselect_b32 s57, 448*3584, 0
    s_waitcnt lgkmcnt(0)
    s_mov_b32 s44, s24
    s_mov_b32 s45, s25
    s_mov_b32 s46, 256
    s_mov_b32 s47, 0x20000
    s_lshr_b32 s56, s2, 3
    s_or_b32 s56, s56, s28
    s_cmp_eq_u32 s56, 0
    s_cbranch_scc0 NONONCE_72
    s_or_b32 s56, s76, 1
    v_mov_b32 v8, s56
    v_mov_b32 v9, 0
    s_mov_b64 exec, 1
    buffer_atomic_cmpswap v[8:9], v6, s[44:47], 0 offen sc1
    s_mov_b64 exec, -1
NONONCE_72:
    s_mov_b32 s32, s4
    s_mov_b32 s33, s5
    s_mov_b32 s34, 1835008
    s_mov_b32 s35, 0x20000
    s_mov_b32 s36, s18
    s_mov_b32 s37, s19
    s_mov_b32 s38, s57
    s_mov_b32 s39, 0x20000
    buffer_load_dwordx4 v[16:19], v4, s[36:39], s31 offen
    s_add_u32 s31, s31, 8*3584
    buffer_load_dwordx4 v[20:23], v4, s[36:39], s31 offen
    s_add_u32 s31, s31, 8*3584
    buffer_load_dwordx4 v[24:27], v4, s[36:39], s31 offen
    s_add_u32 s31, s31, 8*3584
    buffer_load_dwordx4 v[28:31], v4, s[36:39], s31 offen
    s_add_u32 s31, s31, 8*3584
    buffer_load_dwordx4 v[32:35], v4, s[36:39], s31 offen
    s_add_u32 s31, s31, 8*3584
    buffer_load_dwordx4 v[36:39], v4, s[36:39], s31 offen
    s_add_u32 s31, s31, 8*3584
    buffer_load_dwordx4 v[40:43], v4, s[36:39], s31 offen
    s_add_u32 s31, s31, 8*3584
    buffer_load_dword v7, v6, s[44:47], 0 offen sc1
    s_add_u32 s40, s26, 12648448
    s_addc_u32 s41, s27, 0
    s_mov_b32 s42, 131072
    s_mov_b32 s43, 0x20000
    s_mov_b32 s58, 0x00003f80
    s_mov_b32 s59, 0x3f800000
    s_mov_b32 s60, 0x3f803f80
    s_waitcnt vmcnt(7)
    v_dot2_f32_bf16 v80, v16, s58, 0
    v_dot2_f32_bf16 v81, v16, s59, 0
    v_dot2_f32_bf16 v82, v17, s58, 0
    v_dot2_f32_bf16 v83, v17, s59, 0
    v_dot2_f32_bf16 v84, v18, s58, 0
    v_dot2_f32_bf16 v85, v18, s59, 0
    v_dot2_f32_bf16 v86, v19, s58, 0
    v_dot2_f32_bf16 v87, v19, s59, 0
    s_waitcnt vmcnt(6)
    v_dot2_f32_bf16 v80, v20, s58, v80
    v_dot2_f32_bf16 v81, v20, s59, v81
    v_dot2_f32_bf16 v82, v21, s58, v82
    v_dot2_f32_bf16 v83, v21, s59, v83
    v_dot2_f32_bf16 v84, v22, s58, v84
    v_dot2_f32_bf16 v85, v22, s59, v85
    v_dot2_f32_bf16 v86, v23, s58, v86
    v_dot2_f32_bf16 v87, v23, s59, v87
    s_waitcnt vmcnt(5)
    v_dot2_f32_bf16 v80, v24, s58, v80
    v_dot2_f32_bf16 v81, v24, s59, v81
    v_dot2_f32_bf16 v82, v25, s58, v82
    v_dot2_f32_bf16 v83, v25, s59, v83
    v_dot2_f32_bf16 v84, v26, s58, v84
    v_dot2_f32_bf16 v85, v26, s59, v85
    v_dot2_f32_bf16 v86, v27, s58, v86
    v_dot2_f32_bf16 v87, v27, s59, v87
    s_waitcnt vmcnt(4)
    v_dot2_f32_bf16 v80, v28, s58, v80
    v_dot2_f32_bf16 v81, v28, s59, v81
    v_dot2_f32_bf16 v82, v29, s58, v82
    v_dot2_f32_bf16 v83, v29, s59, v83
    v_dot2_f32_bf16 v84, v30, s58, v84
    v_dot2_f32_bf16 v85, v30, s59, v85
    v_dot2_f32_bf16 v86, v31, s58, v86
    v_dot2_f32_bf16 v87, v31, s59, v87
    s_waitcnt vmcnt(3)
    v_dot2_f32_bf16 v80, v32, s58, v80
    v_dot2_f32_bf16 v81, v32, s59, v81
    v_dot2_f32_bf16 v82, v33, s58, v82
    v_dot2_f32_bf16 v83, v33, s59, v83
    v_dot2_f32_bf16 v84, v34, s58, v84
    v_dot2_f32_bf16 v85, v34, s59, v85
    v_dot2_f32_bf16 v86, v35, s58, v86
    v_dot2_f32_bf16 v87, v35, s59, v87
    s_waitcnt vmcnt(2)
    v_dot2_f32_bf16 v80, v36, s58, v80
    v_dot2_f32_bf16 v81, v36, s59, v81
    v_dot2_f32_bf16 v82, v37, s58, v82
    v_dot2_f32_bf16 v83, v37, s59, v83
    v_dot2_f32_bf16 v84, v38, s58, v84
    v_dot2_f32_bf16 v85, v38, s59, v85
    v_dot2_f32_bf16 v86, v39, s58, v86
    v_dot2_f32_bf16 v87, v39, s59, v87
    s_waitcnt vmcnt(1)
    v_dot2_f32_bf16 v80, v40, s58, v80
    v_dot2_f32_bf16 v81, v40, s59, v81
    v_dot2_f32_bf16 v82, v41, s58, v82
    v_dot2_f32_bf16 v83, v41, s59, v83
    v_dot2_f32_bf16 v84, v42, s58, v84
    v_dot2_f32_bf16 v85, v42, s59, v85
    v_dot2_f32_bf16 v86, v43, s58, v86
    v_dot2_f32_bf16 v87, v43, s59, v87
    v_add_f32_dpp v80, v80, v80 row_ror:8 row_mask:0xf bank_mask:0xf
    v_add_f32_dpp v81, v81, v81 row_ror:8 row_mask:0xf bank_mask:0xf
    v_add_f32_dpp v82, v82, v82 row_ror:8 row_mask:0xf bank_mask:0xf
    v_add_f32_dpp v83, v83, v83 row_ror:8 row_mask:0xf bank_mask:0xf
    v_add_f32_dpp v84, v84, v84 row_ror:8 row_mask:0xf bank_mask:0xf
    v_add_f32_dpp v85, v85, v85 row_ror:8 row_mask:0xf bank_mask:0xf
    v_add_f32_dpp v86, v86, v86 row_ror:8 row_mask:0xf bank_mask:0xf
    v_add_f32_dpp v87, v87, v87 row_ror:8 row_mask:0xf bank_mask:0xf
    v_lshrrev_b32 v8, 4, v0
    s_lshl_b32 s56, s28, 2
    v_add_u32 v8, s56, v8
    v_lshlrev_b32 v8, 8, v8
    v_lshl_add_u32 v8, v2, 5, v8
    v_and_b32 v9, 8, v0
    v_lshl_add_u32 v8, v9, 10, v8
    ds_write_b128 v8, v[80:83]
    ds_write_b128 v8, v[84:87] offset:16
    s_waitcnt lgkmcnt(0)
    s_barrier
    v_lshrrev_b32 v8, 3, v0
    v_lshlrev_b32 v8, 10, v8
    s_lshl_b32 s56, s28, 5
    v_lshl_add_u32 v8, v2, 2, v8
    v_add_u32 v8, s56, v8
    ds_read_b32 v80, v8 offset:0
    ds_read_b32 v81, v8 offset:256
    ds_read_b32 v82, v8 offset:512
    ds_read_b32 v83, v8 offset:768
    s_waitcnt lgkmcnt(0)
    v_add_f32 v80, v80, v81
    v_add_f32 v82, v82, v83
    v_add_f32 v80, v80, v82
    s_nop 1
    v_add_f32_dpp v80, v80, v80 row_ror:8 row_mask:0xf bank_mask:0xf
    v_mov_b32 v81, v80
    s_nop 1
    v_permlane16_swap_b32 v80, v81
    v_add_f32 v80, v80, v81
    v_mov_b32 v81, v80
    s_nop 1
    v_permlane32_swap_b32 v80, v81
    v_add_f32 v80, v80, v81
    v_cvt_pk_bf16_f32 v81, v80, v80
    v_and_b32 v81, 0xffff0000, v81
    v_sub_f32 v80, v80, v81
    v_cvt_pk_bf16_f32 v82, v81, v80
    v_cmp_gt_u32 vcc, 8, v0
    v_lshlrev_b32 v8, 3, v0
    v_mov_b32 v9, 0x7fffffff
    v_cndmask_b32 v8, v9, v8, vcc
    s_lshl_b32 s56, s29, 6
    s_add_u32 s62, s56, 65536
    s_cmp_lt_u32 s2, 28
    s_cselect_b32 s62, s62, 0x7ff00000
    v_add_u32 v8, s62, v8
    s_waitcnt vmcnt(0)
    s_movk_i32 s61, 32767
LP_74:
    v_readfirstlane_b32 s77, v7
    s_nop 1
    s_cmp_lg_u32 s77, 0
    s_cbranch_scc1 OK_73
    s_sub_u32 s61, s61, 1
    s_cbranch_scc1 OK_73
    s_sleep 1
    buffer_load_dword v7, v6, s[44:47], 0 offen sc1
    s_waitcnt vmcnt(0)
    s_branch LP_74
OK_73:
    v_mov_b32 v83, s77
    v_mov_b32 v11, s77
    buffer_store_dwordx2 v[82:83], v8, s[40:43], 0 offen sc1
    s_waitcnt vmcnt(0)
    s_barrier
    s_mov_b32 s32, s20
    s_mov_b32 s33, s21
    s_mov_b32 s34, 1605632
    s_mov_b32 s35, 0x20000
    v_lshlrev_b32 v8, 7, v0
    v_min_u32 v9, 48*128, v8
    s_mul_i32 s56, s29, 49*128
    buffer_load_dword v20, v9, s[32:35], s56 offen
    s_lshr_b32 s56, s2, 3
    s_lshl_b32 s56, s56, 3
    s_add_u32 s56, s56, s28
    s_mul_i32 s56, s56, 392*128
    buffer_load_dword v21, v8, s[32:35], s56 offen
    s_add_u32 s56, s56, 8192
    buffer_load_dword v22, v8, s[32:35], s56 offen
    s_add_u32 s56, s56, 8192
    buffer_load_dword v23, v8, s[32:35], s56 offen
    s_add_u32 s56, s56, 8192
    buffer_load_dword v24, v8, s[32:35], s56 offen
    s_add_u32 s56, s56, 8192
    buffer_load_dword v25, v8, s[32:35], s56 offen
    s_add_u32 s56, s56, 8192
    buffer_load_dword v26, v8, s[32:35], s56 offen
    s_add_u32 s56, s56, 8192
    v_min_u32 v8, 7*128, v8
    buffer_load_dword v27, v8, s[32:35], s56 offen
    s_add_u32 s56, s56, 8192
    s_waitcnt vmcnt(0)
L_END:
    s_endpgm
L_CODE_END:
.section .rodata,"a"
.p2align 6
.amdhsa_kernel parallel_sum__ssm_conv_h3__dense_activation_silu__prompt_kernel
  .amdhsa_next_free_vgpr 256
  .amdhsa_next_free_sgpr 102
  .amdhsa_accum_offset 256
  .amdhsa_group_segment_fixed_size 0
  .amdhsa_kernarg_size 96
  .amdhsa_user_sgpr_count 2
  .amdhsa_user_sgpr_kernarg_segment_ptr 1
  .amdhsa_system_sgpr_workgroup_id_x 1
  .amdhsa_float_denorm_mode_32 3
.end_amdhsa_kernel
```
